```python
import torch

def _softmax(x, axis=-1):
    return torch.softmax(x, dim=axis)
def _gelu(x):
    return torch.nn.functional.gelu(x, approximate="tanh")
def _silu(x):
    return torch.nn.functional.silu(x)
def _sigmoid(x):
    return torch.sigmoid(x)
def _layernorm(x, axis=-1, eps=1e-5):
    m = x.mean(dim=axis, keepdim=True)
    v = x.var(dim=axis, keepdim=True, unbiased=False)
    return (x - m) / torch.sqrt(v + eps)
def _scatter_add(tgt, idx, src, axis=0):
    return tgt.clone().index_add_(axis, idx, src)
def _segment_sum(src, seg, n):
    out = torch.zeros((n,) + src.shape[1:], dtype=src.dtype)
    return out.index_add_(0, seg, src)
def _pad(x, pw):
    flat = tuple(v for pair in reversed(pw) for v in pair)
    return torch.nn.functional.pad(x, flat)

kernel_name = 'concat_heads__gqa_block_cached__gqa_block_cached__near_ridge'

def setup_inputs():

    _w = (lambda a: (lambda t: t.to(torch.bfloat16) if t.is_floating_point() else t)(torch.as_tensor(a)))
    def _A_setup():
        B, Sq, D = 8, 80, 448
        Hq, Hkv, Sk, Dh = 16, 8, 1024, 256
        assert Hq % Hkv == 0, (Hq, Hkv)
        return {
            "x": _w((lambda *s: torch.randn(*s, dtype=torch.bfloat16) * 0.8)(B, Sq, D)),
            "k_cache": _w((lambda *s: torch.randn(*s, dtype=torch.bfloat16) * 0.8)(B, Hkv, Sk, Dh)),
            "v_cache": _w((lambda *s: torch.randn(*s, dtype=torch.bfloat16) * 0.05)(B, Hkv, Sk, Dh)),
            "wq": _w((lambda *s: torch.randn(*s, dtype=torch.bfloat16) * 0.8)(D, Hq * Dh) * (D ** -0.5)),
            "wo": _w((lambda *s: torch.randn(*s, dtype=torch.bfloat16) * 0.05)(Hq * Dh, D) * ((Hq * Dh) ** -0.5)),
        }
    _A_in = _A_setup()

    def _B_setup():
        B, Sq, D = 8, 80, 448
        Hq, Hkv, Sk, Dh = 16, 8, 1024, 256
        assert Hq % Hkv == 0, (Hq, Hkv)
        return {
            "x": _w((lambda *s: torch.randn(*s, dtype=torch.bfloat16) * 0.8)(B, Sq, D)),
            "k_cache": _w((lambda *s: torch.randn(*s, dtype=torch.bfloat16) * 0.8)(B, Hkv, Sk, Dh)),
            "v_cache": _w((lambda *s: torch.randn(*s, dtype=torch.bfloat16) * 0.05)(B, Hkv, Sk, Dh)),
            "wq": _w((lambda *s: torch.randn(*s, dtype=torch.bfloat16) * 0.8)(D, Hq * Dh) * (D ** -0.5)),
            "wo": _w((lambda *s: torch.randn(*s, dtype=torch.bfloat16) * 0.05)(Hq * Dh, D) * ((Hq * Dh) ** -0.5)),
        }
    _B_in = _B_setup()

    return {
        "A_x": _A_in["x"],
        "A_k_cache": _A_in["k_cache"],
        "A_v_cache": _A_in["v_cache"],
        "A_wq": _A_in["wq"],
        "A_wo": _A_in["wo"],
        "B_x": _B_in["x"],
        "B_k_cache": _B_in["k_cache"],
        "B_v_cache": _B_in["v_cache"],
        "B_wq": _B_in["wq"],
        "B_wo": _B_in["wo"],
    }

def reference(A_x, A_k_cache, A_v_cache, A_wq, A_wo, B_x, B_k_cache, B_v_cache, B_wq, B_wo):
    def _A_ref(x, k_cache, v_cache, wq, wo):
        B, Sq, D = x.shape
        Hq, Dh = 16, 256
        Hkv = k_cache.shape[1]
        rep = Hq // Hkv
        q = (lambda x, *d: x.permute(*d))((x @ wq).reshape(B, Sq, Hq, Dh), 0, 2, 1, 3)
        k = (lambda x, n, axis: torch.repeat_interleave(x, n, dim=axis))(k_cache, rep, axis=1)
        v = (lambda x, n, axis: torch.repeat_interleave(x, n, dim=axis))(v_cache, rep, axis=1)
        scores = torch.einsum("bhqd,bhkd->bhqk", q, k) * (Dh ** -0.5)
        p = _softmax(scores, axis=-1)
        o = torch.einsum("bhqk,bhkd->bhqd", p, v)
        return (lambda x, *d: x.permute(*d))(o, 0, 2, 1, 3).reshape(B, Sq, Hq * Dh) @ wo

    def _B_ref(x, k_cache, v_cache, wq, wo):
        B, Sq, D = x.shape
        Hq, Dh = 16, 256
        Hkv = k_cache.shape[1]
        rep = Hq // Hkv
        q = (lambda x, *d: x.permute(*d))((x @ wq).reshape(B, Sq, Hq, Dh), 0, 2, 1, 3)
        k = (lambda x, n, axis: torch.repeat_interleave(x, n, dim=axis))(k_cache, rep, axis=1)
        v = (lambda x, n, axis: torch.repeat_interleave(x, n, dim=axis))(v_cache, rep, axis=1)
        scores = torch.einsum("bhqd,bhkd->bhqk", q, k) * (Dh ** -0.5)
        p = _softmax(scores, axis=-1)
        o = torch.einsum("bhqk,bhkd->bhqd", p, v)
        return (lambda x, *d: x.permute(*d))(o, 0, 2, 1, 3).reshape(B, Sq, Hq * Dh) @ wo

    a = _A_ref(A_x, A_k_cache, A_v_cache, A_wq, A_wo)
    b = _B_ref(B_x, B_k_cache, B_v_cache, B_wq, B_wo)
    return torch.concatenate([a, b], axis=-1)
```

```asm
; @launch grid=(256,1,1) block=(512,1,1) lds=163840
.amdgcn_target "amdgcn-amd-amdhsa--gfx950"
.text
.globl concat_heads__gqa_block_cached__gqa_block_cached__near_ridge_kernel
.p2align 8
.type concat_heads__gqa_block_cached__gqa_block_cached__near_ridge_kernel,@function
concat_heads__gqa_block_cached__gqa_block_cached__near_ridge_kernel:
    s_cmp_ge_u32 s2, 256
    s_cbranch_scc1 L_end
    s_and_b32 s3, s2, 7
    s_lshr_b32 s4, s2, 3
    s_lshr_b32 s5, s4, 4
    s_lshr_b32 s6, s4, 1
    s_and_b32 s6, s6, 7
    s_and_b32 s7, s4, 1
    s_lshl_b32 s8, s3, 1
    s_add_u32 s8, s8, s7
    s_mul_i32 s49, s5, 40
    s_add_u32 s50, s0, s49
    s_addc_u32 s51, s1, 0
    s_load_dwordx8 s[12:19], s[50:51], 0
    s_load_dwordx2 s[20:21], s[50:51], 32
    s_load_dwordx2 s[22:23], s[0:1], 96
    s_load_dwordx4 s[56:59], s[0:1], 80
    v_lshrrev_b32 v26, 6, v0
    v_and_b32 v1, 63, v0
    v_readfirstlane_b32 s9, v26
    v_lshlrev_b32 v0, 4, v1
    s_nop 1
    s_and_b32 s10, s9, 3
    s_lshr_b32 s11, s9, 2
    s_mul_i32 s48, s9, 10240
    v_lshrrev_b32 v26, 4, v1
    v_and_b32 v27, 15, v1
    s_lshl_b32 s31, s6, 1
    s_cmp_ge_u32 s31, 14
    s_cselect_b32 s31, 0, s31
    s_lshl_b32 s49, s31, 2
    v_xor_b32 v16, s9, v1
    v_add_u32 v16, s49, v16
    v_subrev_u32 v24, 56, v16
    v_cmp_le_u32 vcc, 56, v16
    s_nop 1
    v_cndmask_b32 v16, v16, v24, vcc
    v_lshlrev_b32 v16, 4, v16
    v_xor_b32 v17, s9, v1
    v_xor_b32 v17, 8, v17
    v_add_u32 v17, s49, v17
    v_subrev_u32 v24, 56, v17
    v_cmp_le_u32 vcc, 56, v17
    s_nop 1
    v_cndmask_b32 v17, v17, v24, vcc
    v_lshlrev_b32 v17, 4, v17
    v_lshrrev_b32 v18, 2, v1
    v_lshlrev_b32 v18, 13, v18
    v_and_b32 v24, 3, v1
    v_lshl_add_u32 v18, v24, 4, v18
    v_lshrrev_b32 v24, 3, v1
    v_and_b32 v25, 7, v1
    v_and_b32 v21, 6, v24
    v_xor_b32 v21, v21, v25
    v_lshlrev_b32 v21, 4, v21
    v_lshl_add_u32 v3, v24, 9, v21
    v_mul_u32_u24 v4, 896, v24
    v_add_u32 v4, v4, v21
    s_mov_b32 s55, 0
    s_mov_b32 s28, 0
    s_mov_b32 s29, 0
    s_lshl_b32 s55, s10, 7
    s_waitcnt lgkmcnt(0)
    s_lshl_b32 s49, s6, 3
    s_add_u32 s49, s49, s3
    s_lshl_b32 s49, s49, 19
    s_lshl_b32 s50, s9, 16
    s_add_u32 s50, s50, s49
    s_add_u32 s32, s14, s50
    s_addc_u32 s33, s15, 0
    s_mov_b32 s34, 65536
    s_mov_b32 s35, 0x00020000
    s_lshl_b32 s49, s8, 9
    s_lshl_b32 s50, s9, 6
    s_add_u32 s49, s49, s50
    s_add_u32 s60, s18, s49
    s_addc_u32 s61, s19, 0
    s_mov_b32 s62, 3661888
    s_mov_b32 s63, 0x00020000
    s_lshl_b32 s30, s31, 18
    s_mul_i32 s49, s6, 71680
    s_add_u32 s24, s12, s49
    s_addc_u32 s25, s13, 0
    s_mov_b32 s26, 71680
    s_mov_b32 s27, 0x00020000
    s_mul_i32 s52, s9, 896
    s_mul_i32 s53, s9, 5120
    s_add_u32 s53, s53, 81920
    s_add_u32 m0, s53, 0
    s_add_u32 s49, s52, 0
    buffer_load_dwordx4 v16, s[24:27], s49 offen lds
    s_add_u32 m0, s53, 40960
    s_add_u32 s49, s52, 7168
    buffer_load_dwordx4 v17, s[24:27], s49 offen lds
    s_add_u32 m0, s53, 1024
    s_add_u32 s49, s52, 14336
    buffer_load_dwordx4 v16, s[24:27], s49 offen lds
    s_add_u32 m0, s53, 41984
    s_add_u32 s49, s52, 21504
    buffer_load_dwordx4 v17, s[24:27], s49 offen lds
    s_add_u32 m0, s53, 2048
    s_add_u32 s49, s52, 28672
    buffer_load_dwordx4 v16, s[24:27], s49 offen lds
    s_add_u32 m0, s53, 43008
    s_add_u32 s49, s52, 35840
    buffer_load_dwordx4 v17, s[24:27], s49 offen lds
    s_add_u32 m0, s53, 3072
    s_add_u32 s49, s52, 43008
    buffer_load_dwordx4 v16, s[24:27], s49 offen lds
    s_add_u32 m0, s53, 44032
    s_add_u32 s49, s52, 50176
    buffer_load_dwordx4 v17, s[24:27], s49 offen lds
    s_add_u32 m0, s53, 4096
    s_add_u32 s49, s52, 57344
    buffer_load_dwordx4 v16, s[24:27], s49 offen lds
    s_add_u32 m0, s53, 45056
    s_add_u32 s49, s52, 64512
    buffer_load_dwordx4 v17, s[24:27], s49 offen lds
    s_add_u32 m0, s48, 0
    s_add_u32 s49, s30, 0
    buffer_load_dwordx4 v18, s[60:63], s49 offen lds
    s_add_u32 m0, s48, 1024
    s_add_u32 s49, s30, 131072
    buffer_load_dwordx4 v18, s[60:63], s49 offen lds
    s_add_u32 s30, s30, 0x40000
    s_cmp_ge_u32 s30, 3670016
    s_cselect_b32 s30, 0, s30
    s_add_u32 m0, s48, 2048
    s_add_u32 s49, s30, 0
    buffer_load_dwordx4 v18, s[60:63], s49 offen lds
    s_add_u32 m0, s48, 3072
    s_add_u32 s49, s30, 131072
    buffer_load_dwordx4 v18, s[60:63], s49 offen lds
    s_add_u32 s30, s30, 0x40000
    s_cmp_ge_u32 s30, 3670016
    s_cselect_b32 s30, 0, s30
    s_add_u32 m0, s48, 4096
    s_add_u32 s49, s30, 0
    buffer_load_dwordx4 v18, s[60:63], s49 offen lds
    s_add_u32 m0, s48, 5120
    s_add_u32 s49, s30, 131072
    buffer_load_dwordx4 v18, s[60:63], s49 offen lds
    s_add_u32 s30, s30, 0x40000
    s_cmp_ge_u32 s30, 3670016
    s_cselect_b32 s30, 0, s30
    s_add_u32 m0, s48, 6144
    s_add_u32 s49, s30, 0
    buffer_load_dwordx4 v18, s[60:63], s49 offen lds
    s_add_u32 m0, s48, 7168
    s_add_u32 s49, s30, 131072
    buffer_load_dwordx4 v18, s[60:63], s49 offen lds
    s_add_u32 s30, s30, 0x40000
    s_cmp_ge_u32 s30, 3670016
    s_cselect_b32 s30, 0, s30
    s_add_u32 m0, s48, 8192
    s_add_u32 s49, s30, 0
    buffer_load_dwordx4 v18, s[60:63], s49 offen lds
    s_add_u32 m0, s48, 9216
    s_add_u32 s49, s30, 131072
    buffer_load_dwordx4 v18, s[60:63], s49 offen lds
    s_lshl_b32 s49, s6, 3
    s_add_u32 s49, s49, s3
    s_lshl_b32 s49, s49, 19
    s_lshl_b32 s50, s11, 18
    s_add_u32 s50, s50, s49
    s_lshl_b32 s51, s10, 7
    s_add_u32 s50, s50, s51
    s_add_u32 s36, s16, s50
    s_addc_u32 s37, s17, 0
    s_mov_b32 s38, 261760
    s_mov_b32 s39, 0x00020000
    s_mul_i32 s50, s8, 229376
    s_lshl_b32 s51, s9, 7
    s_add_u32 s50, s50, s51
    s_add_u32 s40, s20, s50
    s_addc_u32 s41, s21, 0
    s_sub_u32 s42, 229376, s51
    s_cmp_eq_u32 s9, 99
    s_cselect_b32 s42, 0, s42
    s_mov_b32 s43, 0x00020000
    s_lshl_b32 s50, s5, 3
    s_add_u32 s50, s50, s6
    s_mul_i32 s50, s50, 1146880
    s_add_u32 s44, s22, s50
    s_addc_u32 s45, s23, 0
    s_mov_b32 s46, 1146880
    s_mov_b32 s47, 0x00020000
    s_mov_b32 s54, 0x3db8aa3b
    s_mov_b32 s53, 0xffff0000
    s_add_u32 s64, s22, 33554432
    s_addc_u32 s65, s23, 0
    s_add_u32 s49, s6, 0
    s_and_b32 s49, s49, 7
    s_and_b32 s50, s49, 3
    s_lshl_b32 s50, s50, 1
    s_lshr_b32 s49, s49, 2
    s_add_u32 s49, s49, s50
    s_mul_i32 s12, s49, 28672
    s_add_u32 s49, s6, 1
    s_and_b32 s49, s49, 7
    s_and_b32 s50, s49, 3
    s_lshl_b32 s50, s50, 1
    s_lshr_b32 s49, s49, 2
    s_add_u32 s49, s49, s50
    s_mul_i32 s13, s49, 28672
    s_add_u32 s49, s6, 2
    s_and_b32 s49, s49, 7
    s_and_b32 s50, s49, 3
    s_lshl_b32 s50, s50, 1
    s_lshr_b32 s49, s49, 2
    s_add_u32 s49, s49, s50
    s_mul_i32 s14, s49, 28672
    s_add_u32 s49, s6, 3
    s_and_b32 s49, s49, 7
    s_and_b32 s50, s49, 3
    s_lshl_b32 s50, s50, 1
    s_lshr_b32 s49, s49, 2
    s_add_u32 s49, s49, s50
    s_mul_i32 s15, s49, 28672
    s_add_u32 s49, s6, 4
    s_and_b32 s49, s49, 7
    s_and_b32 s50, s49, 3
    s_lshl_b32 s50, s50, 1
    s_lshr_b32 s49, s49, 2
    s_add_u32 s49, s49, s50
    s_mul_i32 s16, s49, 28672
    s_add_u32 s49, s6, 5
    s_and_b32 s49, s49, 7
    s_and_b32 s50, s49, 3
    s_lshl_b32 s50, s50, 1
    s_lshr_b32 s49, s49, 2
    s_add_u32 s49, s49, s50
    s_mul_i32 s17, s49, 28672
    s_add_u32 s49, s6, 6
    s_and_b32 s49, s49, 7
    s_and_b32 s50, s49, 3
    s_lshl_b32 s50, s50, 1
    s_lshr_b32 s49, s49, 2
    s_add_u32 s49, s49, s50
    s_mul_i32 s18, s49, 28672
    s_add_u32 s49, s6, 7
    s_and_b32 s49, s49, 7
    s_and_b32 s50, s49, 3
    s_lshl_b32 s50, s50, 1
    s_lshr_b32 s49, s49, 2
    s_add_u32 s49, s49, s50
    s_mul_i32 s19, s49, 28672
    v_and_b32 v24, 7, v27
    v_and_b32 v25, 6, v27
    v_xor_b32 v5, v25, v26
    v_lshlrev_b32 v5, 4, v5
    v_lshl_add_u32 v5, v24, 7, v5
    v_lshrrev_b32 v24, 3, v27
    v_lshl_add_u32 v5, v24, 10, v5
    v_add_u32 v5, s48, v5
    v_xor_b32 v6, 64, v5
    v_lshrrev_b32 v24, 2, v27
    v_and_b32 v25, 1, v26
    v_lshl_add_u32 v24, v25, 2, v24
    v_lshrrev_b32 v25, 1, v24
    v_lshlrev_b32 v7, 5, v25
    v_lshl_add_u32 v7, v24, 7, v7
    v_and_b32 v25, 3, v27
    v_lshl_add_u32 v7, v25, 3, v7
    v_lshrrev_b32 v25, 1, v26
    v_lshl_add_u32 v7, v25, 10, v7
    v_add_u32 v7, s48, v7
    s_lshl_b32 s49, s11, 6
    v_xor_b32 v7, s49, v7
    v_xor_b32 v8, 32, v7
    v_xor_b32 v9, 64, v7
    v_xor_b32 v10, 0x60, v7
    v_add_u32 v11, 81920, v0
    v_add_u32 v12, 122880, v0
    s_xor_b32 s49, s9, s29
    s_mul_i32 s49, s49, 5120
    v_add_u32 v13, s49, v11
    v_add_u32 v14, s48, v11
    s_xor_b32 s49, s9, 4
    s_mul_i32 s49, s49, 10240
    v_add_u32 v15, s49, v11
    v_lshrrev_b32 v24, 2, v27
    v_and_b32 v25, 1, v26
    v_lshl_add_u32 v24, v25, 3, v24
    v_lshlrev_b32 v2, 6, v24
    v_and_b32 v25, 3, v27
    v_lshl_add_u32 v2, v25, 4, v2
    v_lshrrev_b32 v25, 1, v26
    v_lshl_add_u32 v2, v25, 10, v2
    v_add_u32 v2, s48, v2
    v_mul_u32_u24 v25, 5120, v27
    v_add_u32 v25, 81920, v25
    v_add_u32 v20, 0, v26
    v_xor_b32 v20, v20, v27
    v_lshl_add_u32 v20, v20, 4, v25
    v_add_u32 v21, 4, v26
    v_xor_b32 v21, v21, v27
    v_lshl_add_u32 v21, v21, 4, v25
    v_add_u32 v22, 8, v26
    v_xor_b32 v22, v22, v27
    v_lshl_add_u32 v22, v22, 4, v25
    v_add_u32 v23, 12, v26
    v_xor_b32 v23, v23, v27
    v_lshl_add_u32 v23, v23, 4, v25
    s_lshr_b32 s49, s9, 1
    s_xor_b32 s49, s49, s29
    s_and_b32 s50, s9, 1
    s_lshl_b32 s50, s50, 2
    s_add_u32 s49, s49, s50
    s_mul_i32 s49, s49, 10240
    v_add_u32 v19, s49, v11
    s_cmp_lg_u32 s9, 0
    s_cbranch_scc1 L_nomb
    s_lshl_b32 s49, s2, 7
    v_mov_b32 v24, s49
    v_mov_b32 v25, 0
    s_mov_b64 exec, 1
    global_store_dword v24, v25, s[64:65] sc1
    s_mov_b64 exec, -1
L_nomb:
    s_waitcnt vmcnt(10)
    s_barrier
    s_waitcnt vmcnt(8)
    ds_read_b64_tr_b16 v[80:81], v2 offset:0
    ds_read_b64_tr_b16 v[82:83], v2 offset:256
    ds_read_b64_tr_b16 v[84:85], v2 offset:8
    ds_read_b64_tr_b16 v[86:87], v2 offset:264
    ds_read_b128 v[96:99], v20 offset:0
    ds_read_b128 v[100:103], v20 offset:1024
    ds_read_b128 v[104:107], v20 offset:2048
    ds_read_b128 v[108:111], v20 offset:3072
    ds_read_b128 v[112:115], v20 offset:4096
    ds_read_b128 v[116:119], v21 offset:0
    ds_read_b128 v[120:123], v21 offset:1024
    s_waitcnt vmcnt(6)
    ds_read_b64_tr_b16 v[88:89], v2 offset:2048
    ds_read_b64_tr_b16 v[90:91], v2 offset:2304
    ds_read_b64_tr_b16 v[92:93], v2 offset:2056
    ds_read_b64_tr_b16 v[94:95], v2 offset:2312
    s_waitcnt lgkmcnt(10)
    v_mfma_f32_16x16x32_bf16 v[32:35], v[80:83], v[96:99], 0
    ds_read_b128 v[124:127], v21 offset:2048
    v_mfma_f32_16x16x32_bf16 v[52:55], v[84:87], v[96:99], 0
    s_add_u32 s30, s30, 0x40000
    s_cmp_ge_u32 s30, 3670016
    s_cselect_b32 s30, 0, s30
    s_add_u32 m0, s48, 0
    s_add_u32 s49, s30, 0
    buffer_load_dwordx4 v18, s[60:63], s49 offen lds
    s_waitcnt lgkmcnt(10)
    v_mfma_f32_16x16x32_bf16 v[36:39], v[80:83], v[100:103], 0
    ds_read_b128 v[96:99], v21 offset:3072
    v_mfma_f32_16x16x32_bf16 v[56:59], v[84:87], v[100:103], 0
    s_add_u32 m0, s48, 1024
    s_add_u32 s49, s30, 131072
    buffer_load_dwordx4 v18, s[60:63], s49 offen lds
    s_waitcnt lgkmcnt(10)
    v_mfma_f32_16x16x32_bf16 v[40:43], v[80:83], v[104:107], 0
    ds_read_b128 v[100:103], v21 offset:4096
    v_mfma_f32_16x16x32_bf16 v[60:63], v[84:87], v[104:107], 0
    s_waitcnt lgkmcnt(3)
    s_add_u32 s30, s30, 0x40000
    s_cmp_ge_u32 s30, 3670016
    s_cselect_b32 s30, 0, s30
    s_add_u32 m0, s48, 2048
    s_add_u32 s49, s30, 0
    buffer_load_dwordx4 v18, s[60:63], s49 offen lds
    v_mfma_f32_16x16x32_bf16 v[44:47], v[80:83], v[108:111], 0
    ds_read_b128 v[104:107], v22 offset:0
    v_mfma_f32_16x16x32_bf16 v[64:67], v[84:87], v[108:111], 0
    s_add_u32 m0, s48, 3072
    s_add_u32 s49, s30, 131072
    buffer_load_dwordx4 v18, s[60:63], s49 offen lds
    v_mfma_f32_16x16x32_bf16 v[48:51], v[80:83], v[112:115], 0
    ds_read_b128 v[108:111], v22 offset:1024
    v_mfma_f32_16x16x32_bf16 v[68:71], v[84:87], v[112:115], 0
    s_waitcnt vmcnt(8)
    ds_read_b64_tr_b16 v[80:81], v2 offset:4096
    ds_read_b64_tr_b16 v[82:83], v2 offset:4352
    ds_read_b64_tr_b16 v[84:85], v2 offset:4104
    ds_read_b64_tr_b16 v[86:87], v2 offset:4360
    v_mfma_f32_16x16x32_bf16 v[32:35], v[88:91], v[116:119], v[32:35]
    ds_read_b128 v[112:115], v22 offset:2048
    v_mfma_f32_16x16x32_bf16 v[52:55], v[92:95], v[116:119], v[52:55]
    v_mfma_f32_16x16x32_bf16 v[36:39], v[88:91], v[120:123], v[36:39]
    ds_read_b128 v[116:119], v22 offset:3072
    v_mfma_f32_16x16x32_bf16 v[56:59], v[92:95], v[120:123], v[56:59]
    s_waitcnt lgkmcnt(10)
    v_mfma_f32_16x16x32_bf16 v[40:43], v[88:91], v[124:127], v[40:43]
    ds_read_b128 v[120:123], v22 offset:4096
    v_mfma_f32_16x16x32_bf16 v[60:63], v[92:95], v[124:127], v[60:63]
    s_waitcnt lgkmcnt(3)
    s_add_u32 s30, s30, 0x40000
    s_cmp_ge_u32 s30, 3670016
    s_cselect_b32 s30, 0, s30
    s_add_u32 m0, s48, 4096
    s_add_u32 s49, s30, 0
    buffer_load_dwordx4 v18, s[60:63], s49 offen lds
    v_mfma_f32_16x16x32_bf16 v[44:47], v[88:91], v[96:99], v[44:47]
    ds_read_b128 v[124:127], v23 offset:0
    v_mfma_f32_16x16x32_bf16 v[64:67], v[92:95], v[96:99], v[64:67]
    s_add_u32 m0, s48, 5120
    s_add_u32 s49, s30, 131072
    buffer_load_dwordx4 v18, s[60:63], s49 offen lds
    v_mfma_f32_16x16x32_bf16 v[48:51], v[88:91], v[100:103], v[48:51]
    ds_read_b128 v[96:99], v23 offset:1024
    v_mfma_f32_16x16x32_bf16 v[68:71], v[92:95], v[100:103], v[68:71]
    s_waitcnt vmcnt(8)
    ds_read_b64_tr_b16 v[88:89], v2 offset:6144
    ds_read_b64_tr_b16 v[90:91], v2 offset:6400
    ds_read_b64_tr_b16 v[92:93], v2 offset:6152
    ds_read_b64_tr_b16 v[94:95], v2 offset:6408
    v_mfma_f32_16x16x32_bf16 v[32:35], v[80:83], v[104:107], v[32:35]
    ds_read_b128 v[100:103], v23 offset:2048
    v_mfma_f32_16x16x32_bf16 v[52:55], v[84:87], v[104:107], v[52:55]
    v_mfma_f32_16x16x32_bf16 v[36:39], v[80:83], v[108:111], v[36:39]
    ds_read_b128 v[104:107], v23 offset:3072
    v_mfma_f32_16x16x32_bf16 v[56:59], v[84:87], v[108:111], v[56:59]
    s_waitcnt lgkmcnt(10)
    v_mfma_f32_16x16x32_bf16 v[40:43], v[80:83], v[112:115], v[40:43]
    ds_read_b128 v[108:111], v23 offset:4096
    v_mfma_f32_16x16x32_bf16 v[60:63], v[84:87], v[112:115], v[60:63]
    s_waitcnt lgkmcnt(3)
    s_add_u32 s30, s30, 0x40000
    s_cmp_ge_u32 s30, 3670016
    s_cselect_b32 s30, 0, s30
    s_add_u32 m0, s48, 6144
    s_add_u32 s49, s30, 0
    buffer_load_dwordx4 v18, s[60:63], s49 offen lds
    v_mfma_f32_16x16x32_bf16 v[44:47], v[80:83], v[116:119], v[44:47]
    ds_read_b128 v[112:115], v20 offset:256
    v_mfma_f32_16x16x32_bf16 v[64:67], v[84:87], v[116:119], v[64:67]
    s_add_u32 m0, s48, 7168
    s_add_u32 s49, s30, 131072
    buffer_load_dwordx4 v18, s[60:63], s49 offen lds
    v_mfma_f32_16x16x32_bf16 v[48:51], v[80:83], v[120:123], v[48:51]
    ds_read_b128 v[116:119], v20 offset:1280
    v_mfma_f32_16x16x32_bf16 v[68:71], v[84:87], v[120:123], v[68:71]
    s_waitcnt vmcnt(8)
    ds_read_b64_tr_b16 v[80:81], v2 offset:8192
    ds_read_b64_tr_b16 v[82:83], v2 offset:8448
    ds_read_b64_tr_b16 v[84:85], v2 offset:8200
    ds_read_b64_tr_b16 v[86:87], v2 offset:8456
    v_mfma_f32_16x16x32_bf16 v[32:35], v[88:91], v[124:127], v[32:35]
    ds_read_b128 v[120:123], v20 offset:2304
    v_mfma_f32_16x16x32_bf16 v[52:55], v[92:95], v[124:127], v[52:55]
    v_mfma_f32_16x16x32_bf16 v[36:39], v[88:91], v[96:99], v[36:39]
    ds_read_b128 v[124:127], v20 offset:3328
    v_mfma_f32_16x16x32_bf16 v[56:59], v[92:95], v[96:99], v[56:59]
    s_waitcnt lgkmcnt(10)
    v_mfma_f32_16x16x32_bf16 v[40:43], v[88:91], v[100:103], v[40:43]
    ds_read_b128 v[96:99], v20 offset:4352
    v_mfma_f32_16x16x32_bf16 v[60:63], v[92:95], v[100:103], v[60:63]
    s_waitcnt lgkmcnt(3)
    s_add_u32 s30, s30, 0x40000
    s_cmp_ge_u32 s30, 3670016
    s_cselect_b32 s30, 0, s30
    s_add_u32 m0, s48, 8192
    s_add_u32 s49, s30, 0
    buffer_load_dwordx4 v18, s[60:63], s49 offen lds
    v_mfma_f32_16x16x32_bf16 v[44:47], v[88:91], v[104:107], v[44:47]
    ds_read_b128 v[100:103], v21 offset:256
    v_mfma_f32_16x16x32_bf16 v[64:67], v[92:95], v[104:107], v[64:67]
    s_add_u32 m0, s48, 9216
    s_add_u32 s49, s30, 131072
    buffer_load_dwordx4 v18, s[60:63], s49 offen lds
    v_mfma_f32_16x16x32_bf16 v[48:51], v[88:91], v[108:111], v[48:51]
    ds_read_b128 v[104:107], v21 offset:1280
    v_mfma_f32_16x16x32_bf16 v[68:71], v[92:95], v[108:111], v[68:71]
    s_waitcnt vmcnt(8)
    ds_read_b64_tr_b16 v[88:89], v2 offset:0
    ds_read_b64_tr_b16 v[90:91], v2 offset:256
    ds_read_b64_tr_b16 v[92:93], v2 offset:8
    ds_read_b64_tr_b16 v[94:95], v2 offset:264
    v_mfma_f32_16x16x32_bf16 v[32:35], v[80:83], v[112:115], v[32:35]
    ds_read_b128 v[108:111], v21 offset:2304
    v_mfma_f32_16x16x32_bf16 v[52:55], v[84:87], v[112:115], v[52:55]
    v_mfma_f32_16x16x32_bf16 v[36:39], v[80:83], v[116:119], v[36:39]
    ds_read_b128 v[112:115], v21 offset:3328
    v_mfma_f32_16x16x32_bf16 v[56:59], v[84:87], v[116:119], v[56:59]
    s_waitcnt lgkmcnt(10)
    v_mfma_f32_16x16x32_bf16 v[40:43], v[80:83], v[120:123], v[40:43]
    ds_read_b128 v[116:119], v21 offset:4352
    v_mfma_f32_16x16x32_bf16 v[60:63], v[84:87], v[120:123], v[60:63]
    s_waitcnt lgkmcnt(3)
    s_add_u32 s30, s30, 0x40000
    s_cmp_ge_u32 s30, 3670016
    s_cselect_b32 s30, 0, s30
    s_add_u32 m0, s48, 0
    s_add_u32 s49, s30, 0
    buffer_load_dwordx4 v18, s[60:63], s49 offen lds
    v_mfma_f32_16x16x32_bf16 v[44:47], v[80:83], v[124:127], v[44:47]
    ds_read_b128 v[120:123], v22 offset:256
    v_mfma_f32_16x16x32_bf16 v[64:67], v[84:87], v[124:127], v[64:67]
    s_add_u32 m0, s48, 1024
    s_add_u32 s49, s30, 131072
    buffer_load_dwordx4 v18, s[60:63], s49 offen lds
    v_mfma_f32_16x16x32_bf16 v[48:51], v[80:83], v[96:99], v[48:51]
    ds_read_b128 v[124:127], v22 offset:1280
    v_mfma_f32_16x16x32_bf16 v[68:71], v[84:87], v[96:99], v[68:71]
    s_waitcnt vmcnt(8)
    ds_read_b64_tr_b16 v[80:81], v2 offset:2048
    ds_read_b64_tr_b16 v[82:83], v2 offset:2304
    ds_read_b64_tr_b16 v[84:85], v2 offset:2056
    ds_read_b64_tr_b16 v[86:87], v2 offset:2312
    v_mfma_f32_16x16x32_bf16 v[32:35], v[88:91], v[100:103], v[32:35]
    ds_read_b128 v[96:99], v22 offset:2304
    v_mfma_f32_16x16x32_bf16 v[52:55], v[92:95], v[100:103], v[52:55]
    v_mfma_f32_16x16x32_bf16 v[36:39], v[88:91], v[104:107], v[36:39]
    ds_read_b128 v[100:103], v22 offset:3328
    v_mfma_f32_16x16x32_bf16 v[56:59], v[92:95], v[104:107], v[56:59]
    s_waitcnt lgkmcnt(10)
    v_mfma_f32_16x16x32_bf16 v[40:43], v[88:91], v[108:111], v[40:43]
    ds_read_b128 v[104:107], v22 offset:4352
    v_mfma_f32_16x16x32_bf16 v[60:63], v[92:95], v[108:111], v[60:63]
    s_waitcnt lgkmcnt(3)
    s_add_u32 s30, s30, 0x40000
    s_cmp_ge_u32 s30, 3670016
    s_cselect_b32 s30, 0, s30
    s_add_u32 m0, s48, 2048
    s_add_u32 s49, s30, 0
    buffer_load_dwordx4 v18, s[60:63], s49 offen lds
    v_mfma_f32_16x16x32_bf16 v[44:47], v[88:91], v[112:115], v[44:47]
    ds_read_b128 v[108:111], v23 offset:256
    v_mfma_f32_16x16x32_bf16 v[64:67], v[92:95], v[112:115], v[64:67]
    s_add_u32 m0, s48, 3072
    s_add_u32 s49, s30, 131072
    buffer_load_dwordx4 v18, s[60:63], s49 offen lds
    v_mfma_f32_16x16x32_bf16 v[48:51], v[88:91], v[116:119], v[48:51]
    ds_read_b128 v[112:115], v23 offset:1280
    v_mfma_f32_16x16x32_bf16 v[68:71], v[92:95], v[116:119], v[68:71]
    s_waitcnt vmcnt(8)
    ds_read_b64_tr_b16 v[88:89], v2 offset:4096
    ds_read_b64_tr_b16 v[90:91], v2 offset:4352
    ds_read_b64_tr_b16 v[92:93], v2 offset:4104
    ds_read_b64_tr_b16 v[94:95], v2 offset:4360
    v_mfma_f32_16x16x32_bf16 v[32:35], v[80:83], v[120:123], v[32:35]
    ds_read_b128 v[116:119], v23 offset:2304
    v_mfma_f32_16x16x32_bf16 v[52:55], v[84:87], v[120:123], v[52:55]
    v_mfma_f32_16x16x32_bf16 v[36:39], v[80:83], v[124:127], v[36:39]
    ds_read_b128 v[120:123], v23 offset:3328
    v_mfma_f32_16x16x32_bf16 v[56:59], v[84:87], v[124:127], v[56:59]
    s_waitcnt lgkmcnt(10)
    v_mfma_f32_16x16x32_bf16 v[40:43], v[80:83], v[96:99], v[40:43]
    ds_read_b128 v[124:127], v23 offset:4352
    v_mfma_f32_16x16x32_bf16 v[60:63], v[84:87], v[96:99], v[60:63]
    s_waitcnt lgkmcnt(3)
    s_add_u32 s30, s30, 0x40000
    s_cmp_ge_u32 s30, 3670016
    s_cselect_b32 s30, 0, s30
    s_add_u32 m0, s48, 4096
    s_add_u32 s49, s30, 0
    buffer_load_dwordx4 v18, s[60:63], s49 offen lds
    v_mfma_f32_16x16x32_bf16 v[44:47], v[80:83], v[100:103], v[44:47]
    ds_read_b128 v[96:99], v20 offset:512
    v_mfma_f32_16x16x32_bf16 v[64:67], v[84:87], v[100:103], v[64:67]
    s_add_u32 m0, s48, 5120
    s_add_u32 s49, s30, 131072
    buffer_load_dwordx4 v18, s[60:63], s49 offen lds
    v_mfma_f32_16x16x32_bf16 v[48:51], v[80:83], v[104:107], v[48:51]
    ds_read_b128 v[100:103], v20 offset:1536
    v_mfma_f32_16x16x32_bf16 v[68:71], v[84:87], v[104:107], v[68:71]
    s_waitcnt vmcnt(8)
    ds_read_b64_tr_b16 v[80:81], v2 offset:6144
    ds_read_b64_tr_b16 v[82:83], v2 offset:6400
    ds_read_b64_tr_b16 v[84:85], v2 offset:6152
    ds_read_b64_tr_b16 v[86:87], v2 offset:6408
    v_mfma_f32_16x16x32_bf16 v[32:35], v[88:91], v[108:111], v[32:35]
    ds_read_b128 v[104:107], v20 offset:2560
    v_mfma_f32_16x16x32_bf16 v[52:55], v[92:95], v[108:111], v[52:55]
    v_mfma_f32_16x16x32_bf16 v[36:39], v[88:91], v[112:115], v[36:39]
    ds_read_b128 v[108:111], v20 offset:3584
    v_mfma_f32_16x16x32_bf16 v[56:59], v[92:95], v[112:115], v[56:59]
    s_waitcnt lgkmcnt(10)
    v_mfma_f32_16x16x32_bf16 v[40:43], v[88:91], v[116:119], v[40:43]
    ds_read_b128 v[112:115], v20 offset:4608
    v_mfma_f32_16x16x32_bf16 v[60:63], v[92:95], v[116:119], v[60:63]
    s_waitcnt lgkmcnt(3)
    s_add_u32 s30, s30, 0x40000
    s_cmp_ge_u32 s30, 3670016
    s_cselect_b32 s30, 0, s30
    s_add_u32 m0, s48, 6144
    s_add_u32 s49, s30, 0
    buffer_load_dwordx4 v18, s[60:63], s49 offen lds
    v_mfma_f32_16x16x32_bf16 v[44:47], v[88:91], v[120:123], v[44:47]
    ds_read_b128 v[116:119], v21 offset:512
    v_mfma_f32_16x16x32_bf16 v[64:67], v[92:95], v[120:123], v[64:67]
    s_add_u32 m0, s48, 7168
    s_add_u32 s49, s30, 131072
    buffer_load_dwordx4 v18, s[60:63], s49 offen lds
    v_mfma_f32_16x16x32_bf16 v[48:51], v[88:91], v[124:127], v[48:51]
    ds_read_b128 v[120:123], v21 offset:1536
    v_mfma_f32_16x16x32_bf16 v[68:71], v[92:95], v[124:127], v[68:71]
    s_waitcnt vmcnt(8)
    ds_read_b64_tr_b16 v[88:89], v2 offset:8192
    ds_read_b64_tr_b16 v[90:91], v2 offset:8448
    ds_read_b64_tr_b16 v[92:93], v2 offset:8200
    ds_read_b64_tr_b16 v[94:95], v2 offset:8456
    v_mfma_f32_16x16x32_bf16 v[32:35], v[80:83], v[96:99], v[32:35]
    ds_read_b128 v[124:127], v21 offset:2560
    v_mfma_f32_16x16x32_bf16 v[52:55], v[84:87], v[96:99], v[52:55]
    v_mfma_f32_16x16x32_bf16 v[36:39], v[80:83], v[100:103], v[36:39]
    ds_read_b128 v[96:99], v21 offset:3584
    v_mfma_f32_16x16x32_bf16 v[56:59], v[84:87], v[100:103], v[56:59]
    s_waitcnt lgkmcnt(10)
    v_mfma_f32_16x16x32_bf16 v[40:43], v[80:83], v[104:107], v[40:43]
    ds_read_b128 v[100:103], v21 offset:4608
    v_mfma_f32_16x16x32_bf16 v[60:63], v[84:87], v[104:107], v[60:63]
    s_waitcnt lgkmcnt(3)
    s_add_u32 m0, s48, 8192
    s_xor_b32 s49, s55, 0
    buffer_load_dwordx4 v3, s[32:35], s49 offen lds
    v_mfma_f32_16x16x32_bf16 v[44:47], v[80:83], v[108:111], v[44:47]
    ds_read_b128 v[104:107], v22 offset:512
    v_mfma_f32_16x16x32_bf16 v[64:67], v[84:87], v[108:111], v[64:67]
    s_add_u32 m0, s48, 9216
    s_xor_b32 s49, s55, 4096
    buffer_load_dwordx4 v3, s[32:35], s49 offen lds
    v_mfma_f32_16x16x32_bf16 v[48:51], v[80:83], v[112:115], v[48:51]
    ds_read_b128 v[108:111], v22 offset:1536
    v_mfma_f32_16x16x32_bf16 v[68:71], v[84:87], v[112:115], v[68:71]
    s_waitcnt vmcnt(8)
    ds_read_b64_tr_b16 v[80:81], v2 offset:0
    ds_read_b64_tr_b16 v[82:83], v2 offset:256
    ds_read_b64_tr_b16 v[84:85], v2 offset:8
    ds_read_b64_tr_b16 v[86:87], v2 offset:264
    v_mfma_f32_16x16x32_bf16 v[32:35], v[88:91], v[116:119], v[32:35]
    ds_read_b128 v[112:115], v22 offset:2560
    v_mfma_f32_16x16x32_bf16 v[52:55], v[92:95], v[116:119], v[52:55]
    v_mfma_f32_16x16x32_bf16 v[36:39], v[88:91], v[120:123], v[36:39]
    ds_read_b128 v[116:119], v22 offset:3584
    v_mfma_f32_16x16x32_bf16 v[56:59], v[92:95], v[120:123], v[56:59]
    s_waitcnt lgkmcnt(10)
    v_mfma_f32_16x16x32_bf16 v[40:43], v[88:91], v[124:127], v[40:43]
    ds_read_b128 v[120:123], v22 offset:4608
    v_mfma_f32_16x16x32_bf16 v[60:63], v[92:95], v[124:127], v[60:63]
    s_waitcnt lgkmcnt(3)
    s_add_u32 m0, s48, 0
    s_xor_b32 s49, s55, 8192
    buffer_load_dwordx4 v3, s[32:35], s49 offen lds
    v_mfma_f32_16x16x32_bf16 v[44:47], v[88:91], v[96:99], v[44:47]
    ds_read_b128 v[124:127], v23 offset:512
    v_mfma_f32_16x16x32_bf16 v[64:67], v[92:95], v[96:99], v[64:67]
    s_add_u32 m0, s48, 1024
    s_xor_b32 s49, s55, 12288
    buffer_load_dwordx4 v3, s[32:35], s49 offen lds
    v_mfma_f32_16x16x32_bf16 v[48:51], v[88:91], v[100:103], v[48:51]
    ds_read_b128 v[96:99], v23 offset:1536
    v_mfma_f32_16x16x32_bf16 v[68:71], v[92:95], v[100:103], v[68:71]
    s_waitcnt vmcnt(8)
    ds_read_b64_tr_b16 v[88:89], v2 offset:2048
    ds_read_b64_tr_b16 v[90:91], v2 offset:2304
    ds_read_b64_tr_b16 v[92:93], v2 offset:2056
    ds_read_b64_tr_b16 v[94:95], v2 offset:2312
    v_mfma_f32_16x16x32_bf16 v[32:35], v[80:83], v[104:107], v[32:35]
    ds_read_b128 v[100:103], v23 offset:2560
    v_mfma_f32_16x16x32_bf16 v[52:55], v[84:87], v[104:107], v[52:55]
    v_mfma_f32_16x16x32_bf16 v[36:39], v[80:83], v[108:111], v[36:39]
    ds_read_b128 v[104:107], v23 offset:3584
    v_mfma_f32_16x16x32_bf16 v[56:59], v[84:87], v[108:111], v[56:59]
    s_waitcnt lgkmcnt(10)
    v_mfma_f32_16x16x32_bf16 v[40:43], v[80:83], v[112:115], v[40:43]
    ds_read_b128 v[108:111], v23 offset:4608
    v_mfma_f32_16x16x32_bf16 v[60:63], v[84:87], v[112:115], v[60:63]
    s_waitcnt lgkmcnt(3)
    s_add_u32 m0, s48, 2048
    s_xor_b32 s49, s55, 128
    buffer_load_dwordx4 v3, s[32:35], s49 offen lds
    v_mfma_f32_16x16x32_bf16 v[44:47], v[80:83], v[116:119], v[44:47]
    ds_read_b128 v[112:115], v20 offset:768
    v_mfma_f32_16x16x32_bf16 v[64:67], v[84:87], v[116:119], v[64:67]
    s_add_u32 m0, s48, 3072
    s_xor_b32 s49, s55, 4224
    buffer_load_dwordx4 v3, s[32:35], s49 offen lds
    v_mfma_f32_16x16x32_bf16 v[48:51], v[80:83], v[120:123], v[48:51]
    ds_read_b128 v[116:119], v20 offset:1792
    v_mfma_f32_16x16x32_bf16 v[68:71], v[84:87], v[120:123], v[68:71]
    s_waitcnt vmcnt(8)
    ds_read_b64_tr_b16 v[80:81], v2 offset:4096
    ds_read_b64_tr_b16 v[82:83], v2 offset:4352
    ds_read_b64_tr_b16 v[84:85], v2 offset:4104
    ds_read_b64_tr_b16 v[86:87], v2 offset:4360
    v_mfma_f32_16x16x32_bf16 v[32:35], v[88:91], v[124:127], v[32:35]
    ds_read_b128 v[120:123], v20 offset:2816
    v_mfma_f32_16x16x32_bf16 v[52:55], v[92:95], v[124:127], v[52:55]
    v_mfma_f32_16x16x32_bf16 v[36:39], v[88:91], v[96:99], v[36:39]
    ds_read_b128 v[124:127], v20 offset:3840
    v_mfma_f32_16x16x32_bf16 v[56:59], v[92:95], v[96:99], v[56:59]
    s_waitcnt lgkmcnt(10)
    v_mfma_f32_16x16x32_bf16 v[40:43], v[88:91], v[100:103], v[40:43]
    ds_read_b128 v[96:99], v20 offset:4864
    v_mfma_f32_16x16x32_bf16 v[60:63], v[92:95], v[100:103], v[60:63]
    s_waitcnt lgkmcnt(3)
    s_add_u32 m0, s48, 4096
    s_xor_b32 s49, s55, 8320
    buffer_load_dwordx4 v3, s[32:35], s49 offen lds
    v_mfma_f32_16x16x32_bf16 v[44:47], v[88:91], v[104:107], v[44:47]
    ds_read_b128 v[100:103], v21 offset:768
    v_mfma_f32_16x16x32_bf16 v[64:67], v[92:95], v[104:107], v[64:67]
    s_add_u32 m0, s48, 5120
    s_xor_b32 s49, s55, 12416
    buffer_load_dwordx4 v3, s[32:35], s49 offen lds
    v_mfma_f32_16x16x32_bf16 v[48:51], v[88:91], v[108:111], v[48:51]
    ds_read_b128 v[104:107], v21 offset:1792
    v_mfma_f32_16x16x32_bf16 v[68:71], v[92:95], v[108:111], v[68:71]
    s_waitcnt vmcnt(8)
    ds_read_b64_tr_b16 v[88:89], v2 offset:6144
    ds_read_b64_tr_b16 v[90:91], v2 offset:6400
    ds_read_b64_tr_b16 v[92:93], v2 offset:6152
    ds_read_b64_tr_b16 v[94:95], v2 offset:6408
    v_mfma_f32_16x16x32_bf16 v[32:35], v[80:83], v[112:115], v[32:35]
    ds_read_b128 v[108:111], v21 offset:2816
    v_mfma_f32_16x16x32_bf16 v[52:55], v[84:87], v[112:115], v[52:55]
    v_mfma_f32_16x16x32_bf16 v[36:39], v[80:83], v[116:119], v[36:39]
    ds_read_b128 v[112:115], v21 offset:3840
    v_mfma_f32_16x16x32_bf16 v[56:59], v[84:87], v[116:119], v[56:59]
    s_waitcnt lgkmcnt(10)
    v_mfma_f32_16x16x32_bf16 v[40:43], v[80:83], v[120:123], v[40:43]
    ds_read_b128 v[116:119], v21 offset:4864
    v_mfma_f32_16x16x32_bf16 v[60:63], v[84:87], v[120:123], v[60:63]
    s_waitcnt lgkmcnt(3)
    s_add_u32 m0, s48, 6144
    s_xor_b32 s49, s55, 256
    buffer_load_dwordx4 v3, s[32:35], s49 offen lds
    v_mfma_f32_16x16x32_bf16 v[44:47], v[80:83], v[124:127], v[44:47]
    v_mfma_f32_16x16x32_bf16 v[64:67], v[84:87], v[124:127], v[64:67]
    s_add_u32 m0, s48, 7168
    s_xor_b32 s49, s55, 4352
    buffer_load_dwordx4 v3, s[32:35], s49 offen lds
    v_mfma_f32_16x16x32_bf16 v[48:51], v[80:83], v[96:99], v[48:51]
    v_mfma_f32_16x16x32_bf16 v[68:71], v[84:87], v[96:99], v[68:71]
    v_mfma_f32_16x16x32_bf16 v[32:35], v[88:91], v[100:103], v[32:35]
    v_mfma_f32_16x16x32_bf16 v[52:55], v[92:95], v[100:103], v[52:55]
    v_mfma_f32_16x16x32_bf16 v[36:39], v[88:91], v[104:107], v[36:39]
    v_mfma_f32_16x16x32_bf16 v[56:59], v[92:95], v[104:107], v[56:59]
    s_waitcnt lgkmcnt(2)
    v_mfma_f32_16x16x32_bf16 v[40:43], v[88:91], v[108:111], v[40:43]
    v_mfma_f32_16x16x32_bf16 v[60:63], v[92:95], v[108:111], v[60:63]
    s_waitcnt lgkmcnt(1)
    v_mfma_f32_16x16x32_bf16 v[44:47], v[88:91], v[112:115], v[44:47]
    v_mfma_f32_16x16x32_bf16 v[64:67], v[92:95], v[112:115], v[64:67]
    s_waitcnt lgkmcnt(0)
    v_mfma_f32_16x16x32_bf16 v[48:51], v[88:91], v[116:119], v[48:51]
    v_mfma_f32_16x16x32_bf16 v[68:71], v[92:95], v[116:119], v[68:71]
    v_cvt_pk_bf16_f32 v128, v32, v33
    v_cvt_pk_bf16_f32 v129, v34, v35
    v_cvt_pk_bf16_f32 v130, v52, v53
    v_cvt_pk_bf16_f32 v131, v54, v55
    v_cvt_pk_bf16_f32 v132, v36, v37
    v_cvt_pk_bf16_f32 v133, v38, v39
    v_cvt_pk_bf16_f32 v134, v56, v57
    v_cvt_pk_bf16_f32 v135, v58, v59
    v_cvt_pk_bf16_f32 v136, v40, v41
    v_cvt_pk_bf16_f32 v137, v42, v43
    v_cvt_pk_bf16_f32 v138, v60, v61
    v_cvt_pk_bf16_f32 v139, v62, v63
    v_cvt_pk_bf16_f32 v140, v44, v45
    v_cvt_pk_bf16_f32 v141, v46, v47
    v_cvt_pk_bf16_f32 v142, v64, v65
    v_cvt_pk_bf16_f32 v143, v66, v67
    v_cvt_pk_bf16_f32 v144, v48, v49
    v_cvt_pk_bf16_f32 v145, v50, v51
    v_cvt_pk_bf16_f32 v146, v68, v69
    v_cvt_pk_bf16_f32 v147, v70, v71
    s_barrier
    ds_write_b128 v19, v[128:131] offset:0
    ds_write_b128 v19, v[132:135] offset:1024
    ds_write_b128 v19, v[136:139] offset:2048
    ds_write_b128 v19, v[140:143] offset:3072
    ds_write_b128 v19, v[144:147] offset:4096
    v_mov_b32 v24, 0xff800000
    v_lshrrev_b32 v25, 1, v0
    v_add_u32 v25, 122880, v25
    v_mov_b32 v25, v25
    ds_write_b32 v25, v24 offset:35840
    ds_write_b32 v25, v24 offset:35844
    s_waitcnt lgkmcnt(0)
    s_barrier
    s_xor_b32 s49, s10, 0
    s_mul_i32 s49, s49, 10240
    v_add_u32 v2, s49, v11
    s_xor_b32 s49, s10, 1
    s_mul_i32 s49, s49, 10240
    v_add_u32 v12, s49, v11
    s_xor_b32 s49, s10, 2
    s_mul_i32 s49, s49, 10240
    v_add_u32 v14, s49, v11
    s_xor_b32 s49, s10, 3
    s_mul_i32 s49, s49, 10240
    v_add_u32 v15, s49, v11
    s_waitcnt vmcnt(6)
    ds_read_b128 v[192:195], v5 offset:8192
    ds_read_b128 v[196:199], v6 offset:8192
    ds_read_b128 v[200:203], v5 offset:0
    ds_read_b128 v[204:207], v6 offset:0
    ds_read_b128 v[224:227], v2 offset:0
    ds_read_b128 v[228:231], v2 offset:1024
    ds_read_b128 v[232:235], v2 offset:2048
    ds_read_b128 v[236:239], v2 offset:3072
    ds_read_b128 v[240:243], v2 offset:4096
    ds_read_b128 v[244:247], v2 offset:40960
    s_waitcnt vmcnt(2)
    ds_read_b128 v[208:211], v5 offset:2048
    ds_read_b128 v[212:215], v6 offset:2048
    ds_read_b128 v[216:219], v5 offset:4096
    ds_read_b128 v[220:223], v6 offset:4096
    s_waitcnt lgkmcnt(9)
    v_mfma_f32_16x16x32_bf16 v[112:115], v[192:195], v[224:227], 0
    ds_read_b128 v[248:251], v2 offset:41984
    v_mfma_f32_16x16x32_bf16 v[132:135], v[200:203], v[224:227], 0
    s_add_u32 m0, s48, 8192
    s_xor_b32 s49, s55, 8448
    buffer_load_dwordx4 v3, s[32:35], s49 offen lds
    s_waitcnt lgkmcnt(9)
    v_mfma_f32_16x16x32_bf16 v[116:119], v[192:195], v[228:231], 0
    ds_read_b128 v[224:227], v2 offset:43008
    v_mfma_f32_16x16x32_bf16 v[136:139], v[200:203], v[228:231], 0
    s_add_u32 m0, s48, 9216
    s_xor_b32 s49, s55, 12544
    buffer_load_dwordx4 v3, s[32:35], s49 offen lds
    s_waitcnt lgkmcnt(9)
    v_mfma_f32_16x16x32_bf16 v[120:123], v[192:195], v[232:235], 0
    ds_read_b128 v[228:231], v2 offset:44032
    v_mfma_f32_16x16x32_bf16 v[140:143], v[200:203], v[232:235], 0
    s_add_u32 m0, s48, 0
    s_xor_b32 s49, s55, 384
    buffer_load_dwordx4 v3, s[32:35], s49 offen lds
    s_waitcnt lgkmcnt(9)
    v_mfma_f32_16x16x32_bf16 v[124:127], v[192:195], v[236:239], 0
    ds_read_b128 v[232:235], v2 offset:45056
    v_mfma_f32_16x16x32_bf16 v[144:147], v[200:203], v[236:239], 0
    s_waitcnt lgkmcnt(4)
    s_add_u32 m0, s48, 1024
    s_xor_b32 s49, s55, 4480
    buffer_load_dwordx4 v3, s[32:35], s49 offen lds
    v_mfma_f32_16x16x32_bf16 v[128:131], v[192:195], v[240:243], 0
    ds_read_b128 v[236:239], v12 offset:0
    v_mfma_f32_16x16x32_bf16 v[148:151], v[200:203], v[240:243], 0
    s_add_u32 m0, s48, 2048
    s_xor_b32 s49, s55, 8576
    buffer_load_dwordx4 v3, s[32:35], s49 offen lds
    v_mfma_f32_16x16x32_bf16 v[112:115], v[196:199], v[244:247], v[112:115]
    ds_read_b128 v[240:243], v12 offset:1024
    v_mfma_f32_16x16x32_bf16 v[132:135], v[204:207], v[244:247], v[132:135]
    s_add_u32 m0, s48, 3072
    s_xor_b32 s49, s55, 12672
    buffer_load_dwordx4 v3, s[32:35], s49 offen lds
    s_waitcnt lgkmcnt(5)
    v_mfma_f32_16x16x32_bf16 v[116:119], v[196:199], v[248:251], v[116:119]
    ds_read_b128 v[244:247], v12 offset:2048
    v_mfma_f32_16x16x32_bf16 v[136:139], v[204:207], v[248:251], v[136:139]
    s_add_u32 m0, s48, 4096
    s_xor_b32 s49, s55, 16384
    buffer_load_dwordx4 v3, s[32:35], s49 offen lds
    s_waitcnt lgkmcnt(5)
    v_mfma_f32_16x16x32_bf16 v[120:123], v[196:199], v[224:227], v[120:123]
    ds_read_b128 v[248:251], v12 offset:3072
    v_mfma_f32_16x16x32_bf16 v[140:143], v[204:207], v[224:227], v[140:143]
    s_add_u32 m0, s48, 5120
    s_xor_b32 s49, s55, 20480
    buffer_load_dwordx4 v3, s[32:35], s49 offen lds
    s_waitcnt lgkmcnt(5)
    v_mfma_f32_16x16x32_bf16 v[124:127], v[196:199], v[228:231], v[124:127]
    ds_read_b128 v[224:227], v12 offset:4096
    v_mfma_f32_16x16x32_bf16 v[144:147], v[204:207], v[228:231], v[144:147]
    s_waitcnt lgkmcnt(5)
    v_mfma_f32_16x16x32_bf16 v[128:131], v[196:199], v[232:235], v[128:131]
    ds_read_b128 v[228:231], v12 offset:40960
    v_mfma_f32_16x16x32_bf16 v[148:151], v[204:207], v[232:235], v[148:151]
    s_waitcnt vmcnt(6)
    ds_read_b128 v[192:195], v5 offset:6144
    ds_read_b128 v[196:199], v6 offset:6144
    ds_read_b128 v[200:203], v5 offset:8192
    ds_read_b128 v[204:207], v6 offset:8192
    s_waitcnt lgkmcnt(9)
    v_mfma_f32_16x16x32_bf16 v[112:115], v[208:211], v[236:239], v[112:115]
    ds_read_b128 v[232:235], v12 offset:41984
    v_mfma_f32_16x16x32_bf16 v[132:135], v[216:219], v[236:239], v[132:135]
    s_waitcnt lgkmcnt(9)
    v_mfma_f32_16x16x32_bf16 v[116:119], v[208:211], v[240:243], v[116:119]
    ds_read_b128 v[236:239], v12 offset:43008
    v_mfma_f32_16x16x32_bf16 v[136:139], v[216:219], v[240:243], v[136:139]
    s_waitcnt lgkmcnt(9)
    v_mfma_f32_16x16x32_bf16 v[120:123], v[208:211], v[244:247], v[120:123]
    ds_read_b128 v[240:243], v12 offset:44032
    v_mfma_f32_16x16x32_bf16 v[140:143], v[216:219], v[244:247], v[140:143]
    s_waitcnt lgkmcnt(9)
    v_mfma_f32_16x16x32_bf16 v[124:127], v[208:211], v[248:251], v[124:127]
    ds_read_b128 v[244:247], v12 offset:45056
    v_mfma_f32_16x16x32_bf16 v[144:147], v[216:219], v[248:251], v[144:147]
    s_waitcnt lgkmcnt(4)
    s_add_u32 m0, s48, 6144
    s_xor_b32 s49, s55, 24576
    buffer_load_dwordx4 v3, s[32:35], s49 offen lds
    v_mfma_f32_16x16x32_bf16 v[128:131], v[208:211], v[224:227], v[128:131]
    ds_read_b128 v[248:251], v14 offset:0
    v_mfma_f32_16x16x32_bf16 v[148:151], v[216:219], v[224:227], v[148:151]
    s_add_u32 m0, s48, 7168
    s_xor_b32 s49, s55, 28672
    buffer_load_dwordx4 v3, s[32:35], s49 offen lds
    v_mfma_f32_16x16x32_bf16 v[112:115], v[212:215], v[228:231], v[112:115]
    ds_read_b128 v[224:227], v14 offset:1024
    v_mfma_f32_16x16x32_bf16 v[132:135], v[220:223], v[228:231], v[132:135]
    s_add_u32 m0, s48, 8192
    s_xor_b32 s49, s55, 16512
    buffer_load_dwordx4 v3, s[32:35], s49 offen lds
    s_waitcnt lgkmcnt(5)
    v_mfma_f32_16x16x32_bf16 v[116:119], v[212:215], v[232:235], v[116:119]
    ds_read_b128 v[228:231], v14 offset:2048
    v_mfma_f32_16x16x32_bf16 v[136:139], v[220:223], v[232:235], v[136:139]
    s_add_u32 m0, s48, 9216
    s_xor_b32 s49, s55, 20608
    buffer_load_dwordx4 v3, s[32:35], s49 offen lds
    s_waitcnt lgkmcnt(5)
    v_mfma_f32_16x16x32_bf16 v[120:123], v[212:215], v[236:239], v[120:123]
    ds_read_b128 v[232:235], v14 offset:3072
    v_mfma_f32_16x16x32_bf16 v[140:143], v[220:223], v[236:239], v[140:143]
    s_waitcnt lgkmcnt(5)
    v_mfma_f32_16x16x32_bf16 v[124:127], v[212:215], v[240:243], v[124:127]
    ds_read_b128 v[236:239], v14 offset:4096
    v_mfma_f32_16x16x32_bf16 v[144:147], v[220:223], v[240:243], v[144:147]
    s_waitcnt lgkmcnt(5)
    v_mfma_f32_16x16x32_bf16 v[128:131], v[212:215], v[244:247], v[128:131]
    ds_read_b128 v[240:243], v14 offset:40960
    v_mfma_f32_16x16x32_bf16 v[148:151], v[220:223], v[244:247], v[148:151]
    s_waitcnt vmcnt(6)
    ds_read_b128 v[208:211], v5 offset:0
    ds_read_b128 v[212:215], v6 offset:0
    ds_read_b128 v[216:219], v5 offset:2048
    ds_read_b128 v[220:223], v6 offset:2048
    s_waitcnt lgkmcnt(9)
    v_mfma_f32_16x16x32_bf16 v[112:115], v[192:195], v[248:251], v[112:115]
    ds_read_b128 v[244:247], v14 offset:41984
    v_mfma_f32_16x16x32_bf16 v[132:135], v[200:203], v[248:251], v[132:135]
    s_waitcnt lgkmcnt(9)
    v_mfma_f32_16x16x32_bf16 v[116:119], v[192:195], v[224:227], v[116:119]
    ds_read_b128 v[248:251], v14 offset:43008
    v_mfma_f32_16x16x32_bf16 v[136:139], v[200:203], v[224:227], v[136:139]
    s_waitcnt lgkmcnt(9)
    v_mfma_f32_16x16x32_bf16 v[120:123], v[192:195], v[228:231], v[120:123]
    ds_read_b128 v[224:227], v14 offset:44032
    v_mfma_f32_16x16x32_bf16 v[140:143], v[200:203], v[228:231], v[140:143]
    s_waitcnt lgkmcnt(9)
    v_mfma_f32_16x16x32_bf16 v[124:127], v[192:195], v[232:235], v[124:127]
    ds_read_b128 v[228:231], v14 offset:45056
    v_mfma_f32_16x16x32_bf16 v[144:147], v[200:203], v[232:235], v[144:147]
    s_waitcnt lgkmcnt(4)
    s_add_u32 m0, s48, 0
    s_xor_b32 s49, s55, 24704
    buffer_load_dwordx4 v3, s[32:35], s49 offen lds
    v_mfma_f32_16x16x32_bf16 v[128:131], v[192:195], v[236:239], v[128:131]
    ds_read_b128 v[232:235], v15 offset:0
    v_mfma_f32_16x16x32_bf16 v[148:151], v[200:203], v[236:239], v[148:151]
    s_add_u32 m0, s48, 1024
    s_xor_b32 s49, s55, 28800
    buffer_load_dwordx4 v3, s[32:35], s49 offen lds
    v_mfma_f32_16x16x32_bf16 v[112:115], v[196:199], v[240:243], v[112:115]
    ds_read_b128 v[236:239], v15 offset:1024
    v_mfma_f32_16x16x32_bf16 v[132:135], v[204:207], v[240:243], v[132:135]
    s_add_u32 m0, s48, 2048
    s_xor_b32 s49, s55, 16640
    buffer_load_dwordx4 v3, s[32:35], s49 offen lds
    s_waitcnt lgkmcnt(5)
    v_mfma_f32_16x16x32_bf16 v[116:119], v[196:199], v[244:247], v[116:119]
    ds_read_b128 v[240:243], v15 offset:2048
    v_mfma_f32_16x16x32_bf16 v[136:139], v[204:207], v[244:247], v[136:139]
    s_add_u32 m0, s48, 3072
    s_xor_b32 s49, s55, 20736
    buffer_load_dwordx4 v3, s[32:35], s49 offen lds
    s_waitcnt lgkmcnt(5)
    v_mfma_f32_16x16x32_bf16 v[120:123], v[196:199], v[248:251], v[120:123]
    ds_read_b128 v[244:247], v15 offset:3072
    v_mfma_f32_16x16x32_bf16 v[140:143], v[204:207], v[248:251], v[140:143]
    s_waitcnt lgkmcnt(5)
    v_mfma_f32_16x16x32_bf16 v[124:127], v[196:199], v[224:227], v[124:127]
    ds_read_b128 v[248:251], v15 offset:4096
    v_mfma_f32_16x16x32_bf16 v[144:147], v[204:207], v[224:227], v[144:147]
    s_waitcnt lgkmcnt(5)
    v_mfma_f32_16x16x32_bf16 v[128:131], v[196:199], v[228:231], v[128:131]
    ds_read_b128 v[224:227], v15 offset:40960
    v_mfma_f32_16x16x32_bf16 v[148:151], v[204:207], v[228:231], v[148:151]
    s_waitcnt vmcnt(6)
    ds_read_b128 v[192:195], v5 offset:4096
    ds_read_b128 v[196:199], v6 offset:4096
    ds_read_b128 v[200:203], v5 offset:6144
    ds_read_b128 v[204:207], v6 offset:6144
    s_waitcnt lgkmcnt(9)
    v_mfma_f32_16x16x32_bf16 v[112:115], v[208:211], v[232:235], v[112:115]
    ds_read_b128 v[228:231], v15 offset:41984
    v_mfma_f32_16x16x32_bf16 v[132:135], v[216:219], v[232:235], v[132:135]
    s_waitcnt lgkmcnt(9)
    v_mfma_f32_16x16x32_bf16 v[116:119], v[208:211], v[236:239], v[116:119]
    ds_read_b128 v[232:235], v15 offset:43008
    v_mfma_f32_16x16x32_bf16 v[136:139], v[216:219], v[236:239], v[136:139]
    s_waitcnt lgkmcnt(9)
    v_mfma_f32_16x16x32_bf16 v[120:123], v[208:211], v[240:243], v[120:123]
    ds_read_b128 v[236:239], v15 offset:44032
    v_mfma_f32_16x16x32_bf16 v[140:143], v[216:219], v[240:243], v[140:143]
    s_waitcnt lgkmcnt(9)
    v_mfma_f32_16x16x32_bf16 v[124:127], v[208:211], v[244:247], v[124:127]
    ds_read_b128 v[240:243], v15 offset:45056
    v_mfma_f32_16x16x32_bf16 v[144:147], v[216:219], v[244:247], v[144:147]
    s_waitcnt lgkmcnt(4)
    s_add_u32 m0, s48, 4096
    s_xor_b32 s49, s55, 24832
    buffer_load_dwordx4 v3, s[32:35], s49 offen lds
    v_mfma_f32_16x16x32_bf16 v[128:131], v[208:211], v[248:251], v[128:131]
    ds_read_b128 v[244:247], v2 offset:0
    v_mfma_f32_16x16x32_bf16 v[148:151], v[216:219], v[248:251], v[148:151]
    s_add_u32 m0, s48, 5120
    s_xor_b32 s49, s55, 28928
    buffer_load_dwordx4 v3, s[32:35], s49 offen lds
    v_mfma_f32_16x16x32_bf16 v[112:115], v[212:215], v[224:227], v[112:115]
    ds_read_b128 v[248:251], v2 offset:1024
    v_mfma_f32_16x16x32_bf16 v[132:135], v[220:223], v[224:227], v[132:135]
    s_add_u32 m0, s48, 6144
    s_xor_b32 s49, s55, 16768
    buffer_load_dwordx4 v3, s[32:35], s49 offen lds
    s_waitcnt lgkmcnt(5)
    v_mfma_f32_16x16x32_bf16 v[116:119], v[212:215], v[228:231], v[116:119]
    ds_read_b128 v[224:227], v2 offset:2048
    v_mfma_f32_16x16x32_bf16 v[136:139], v[220:223], v[228:231], v[136:139]
    s_add_u32 m0, s48, 7168
    s_xor_b32 s49, s55, 20864
    buffer_load_dwordx4 v3, s[32:35], s49 offen lds
    s_waitcnt lgkmcnt(5)
    v_mfma_f32_16x16x32_bf16 v[120:123], v[212:215], v[232:235], v[120:123]
    ds_read_b128 v[228:231], v2 offset:3072
    v_mfma_f32_16x16x32_bf16 v[140:143], v[220:223], v[232:235], v[140:143]
    s_waitcnt lgkmcnt(5)
    v_mfma_f32_16x16x32_bf16 v[124:127], v[212:215], v[236:239], v[124:127]
    ds_read_b128 v[232:235], v2 offset:4096
    v_mfma_f32_16x16x32_bf16 v[144:147], v[220:223], v[236:239], v[144:147]
    s_waitcnt lgkmcnt(5)
    v_mfma_f32_16x16x32_bf16 v[128:131], v[212:215], v[240:243], v[128:131]
    ds_read_b128 v[236:239], v2 offset:40960
    v_mfma_f32_16x16x32_bf16 v[148:151], v[220:223], v[240:243], v[148:151]
    s_barrier
    s_waitcnt vmcnt(6)
    ds_read_b128 v[208:211], v5 offset:8192
    ds_read_b128 v[212:215], v6 offset:8192
    ds_read_b128 v[216:219], v5 offset:0
    ds_read_b128 v[220:223], v6 offset:0
    s_waitcnt lgkmcnt(9)
    v_mfma_f32_16x16x32_bf16 v[152:155], v[192:195], v[244:247], 0
    ds_read_b128 v[240:243], v2 offset:41984
    v_mfma_f32_16x16x32_bf16 v[172:175], v[200:203], v[244:247], 0
    s_waitcnt lgkmcnt(9)
    v_mfma_f32_16x16x32_bf16 v[156:159], v[192:195], v[248:251], 0
    ds_read_b128 v[244:247], v2 offset:43008
    v_mfma_f32_16x16x32_bf16 v[176:179], v[200:203], v[248:251], 0
    s_waitcnt lgkmcnt(9)
    v_mfma_f32_16x16x32_bf16 v[160:163], v[192:195], v[224:227], 0
    ds_read_b128 v[248:251], v2 offset:44032
    v_max3_f32 v252, v112, v113, v114
    v_max3_f32 v253, v115, v132, v133
    v_max3_f32 v252, v252, v134, v135
    v_mfma_f32_16x16x32_bf16 v[180:183], v[200:203], v[224:227], 0
    v_max_f32 v252, v252, v253
    v_mul_f32 v252, s54, v252
    v_ceil_f32 v16, v252
    s_waitcnt lgkmcnt(9)
    v_mfma_f32_16x16x32_bf16 v[164:167], v[192:195], v[228:231], 0
    ds_read_b128 v[224:227], v2 offset:45056
    v_fma_f32 v112, v112, s54, -v16
    v_fma_f32 v113, v113, s54, -v16
    v_fma_f32 v114, v114, s54, -v16
    v_mfma_f32_16x16x32_bf16 v[184:187], v[200:203], v[228:231], 0
    v_fma_f32 v115, v115, s54, -v16
    v_fma_f32 v132, v132, s54, -v16
    v_fma_f32 v133, v133, s54, -v16
    s_waitcnt lgkmcnt(4)
    s_add_u32 m0, s48, 8192
    s_xor_b32 s49, s55, 24960
    buffer_load_dwordx4 v3, s[32:35], s49 offen lds
    v_mfma_f32_16x16x32_bf16 v[168:171], v[192:195], v[232:235], 0
    ds_read_b128 v[228:231], v12 offset:0
    v_fma_f32 v134, v134, s54, -v16
    v_fma_f32 v135, v135, s54, -v16
    v_exp_f32 v112, v112
    v_mfma_f32_16x16x32_bf16 v[188:191], v[200:203], v[232:235], 0
    v_exp_f32 v113, v113
    v_exp_f32 v114, v114
    v_exp_f32 v115, v115
    s_add_u32 m0, s48, 9216
    s_xor_b32 s49, s55, 29056
    buffer_load_dwordx4 v3, s[32:35], s49 offen lds
    v_mfma_f32_16x16x32_bf16 v[152:155], v[196:199], v[236:239], v[152:155]
    ds_read_b128 v[232:235], v12 offset:1024
    v_exp_f32 v132, v132
    v_exp_f32 v133, v133
    v_exp_f32 v134, v134
    v_mfma_f32_16x16x32_bf16 v[172:175], v[204:207], v[236:239], v[172:175]
    v_exp_f32 v135, v135
    v_cvt_pk_bf16_f32 v32, v112, v113
    v_cvt_pk_bf16_f32 v33, v114, v115
    s_add_u32 m0, s48, 0
    s_xor_b32 s49, s55, 32768
    buffer_load_dwordx4 v3, s[32:35], s49 offen lds
    s_waitcnt lgkmcnt(5)
    v_mfma_f32_16x16x32_bf16 v[156:159], v[196:199], v[240:243], v[156:159]
    ds_read_b128 v[236:239], v12 offset:2048
    v_cvt_pk_bf16_f32 v34, v132, v133
    v_cvt_pk_bf16_f32 v35, v134, v135
    v_add_f32 v112, v112, v113
    v_mfma_f32_16x16x32_bf16 v[176:179], v[204:207], v[240:243], v[176:179]
    v_add_f32 v114, v114, v115
    v_add_f32 v132, v132, v133
    v_add_f32 v134, v134, v135
    s_add_u32 m0, s48, 1024
    s_xor_b32 s49, s55, 36864
    buffer_load_dwordx4 v3, s[32:35], s49 offen lds
    s_waitcnt lgkmcnt(5)
    v_mfma_f32_16x16x32_bf16 v[160:163], v[196:199], v[244:247], v[160:163]
    ds_read_b128 v[240:243], v12 offset:3072
    v_add_f32 v112, v112, v114
    v_add_f32 v132, v132, v134
    v_add_f32 v21, v112, v132
    v_mfma_f32_16x16x32_bf16 v[180:183], v[204:207], v[244:247], v[180:183]
    v_max3_f32 v254, v116, v117, v118
    v_max3_f32 v255, v119, v136, v137
    v_max3_f32 v254, v254, v138, v139
    s_waitcnt lgkmcnt(5)
    v_mfma_f32_16x16x32_bf16 v[164:167], v[196:199], v[248:251], v[164:167]
    ds_read_b128 v[244:247], v12 offset:4096
    v_max_f32 v254, v254, v255
    v_mul_f32 v254, s54, v254
    v_ceil_f32 v17, v254
    v_mfma_f32_16x16x32_bf16 v[184:187], v[204:207], v[248:251], v[184:187]
    v_fma_f32 v116, v116, s54, -v17
    v_fma_f32 v117, v117, s54, -v17
    v_fma_f32 v118, v118, s54, -v17
    s_waitcnt lgkmcnt(5)
    v_mfma_f32_16x16x32_bf16 v[168:171], v[196:199], v[224:227], v[168:171]
    ds_read_b128 v[248:251], v12 offset:40960
    v_fma_f32 v119, v119, s54, -v17
    v_fma_f32 v136, v136, s54, -v17
    v_fma_f32 v137, v137, s54, -v17
    v_mfma_f32_16x16x32_bf16 v[188:191], v[204:207], v[224:227], v[188:191]
    v_fma_f32 v138, v138, s54, -v17
    v_fma_f32 v139, v139, s54, -v17
    v_exp_f32 v116, v116
    s_waitcnt vmcnt(6)
    ds_read_b128 v[192:195], v5 offset:2048
    ds_read_b128 v[196:199], v6 offset:2048
    ds_read_b128 v[200:203], v5 offset:4096
    ds_read_b128 v[204:207], v6 offset:4096
    s_waitcnt lgkmcnt(9)
    v_mfma_f32_16x16x32_bf16 v[152:155], v[208:211], v[228:231], v[152:155]
    ds_read_b128 v[224:227], v12 offset:41984
    v_exp_f32 v117, v117
    v_exp_f32 v118, v118
    v_exp_f32 v119, v119
    v_mfma_f32_16x16x32_bf16 v[172:175], v[216:219], v[228:231], v[172:175]
    v_exp_f32 v136, v136
    v_exp_f32 v137, v137
    v_exp_f32 v138, v138
    s_waitcnt lgkmcnt(9)
    v_mfma_f32_16x16x32_bf16 v[156:159], v[208:211], v[232:235], v[156:159]
    ds_read_b128 v[228:231], v12 offset:43008
    v_exp_f32 v139, v139
    v_cvt_pk_bf16_f32 v36, v116, v117
    v_cvt_pk_bf16_f32 v37, v118, v119
    v_mfma_f32_16x16x32_bf16 v[176:179], v[216:219], v[232:235], v[176:179]
    v_cvt_pk_bf16_f32 v38, v136, v137
    v_cvt_pk_bf16_f32 v39, v138, v139
    v_add_f32 v116, v116, v117
    s_waitcnt lgkmcnt(9)
    v_mfma_f32_16x16x32_bf16 v[160:163], v[208:211], v[236:239], v[160:163]
    ds_read_b128 v[232:235], v12 offset:44032
    v_add_f32 v118, v118, v119
    v_add_f32 v136, v136, v137
    v_add_f32 v138, v138, v139
    v_mfma_f32_16x16x32_bf16 v[180:183], v[216:219], v[236:239], v[180:183]
    v_add_f32 v116, v116, v118
    v_add_f32 v136, v136, v138
    v_add_f32 v22, v116, v136
    s_waitcnt lgkmcnt(9)
    v_mfma_f32_16x16x32_bf16 v[164:167], v[208:211], v[240:243], v[164:167]
    ds_read_b128 v[236:239], v12 offset:45056
    v_max3_f32 v252, v120, v121, v122
    v_max3_f32 v253, v123, v140, v141
    v_max3_f32 v252, v252, v142, v143
    v_mfma_f32_16x16x32_bf16 v[184:187], v[216:219], v[240:243], v[184:187]
    v_max_f32 v252, v252, v253
    v_mul_f32 v252, s54, v252
    v_ceil_f32 v18, v252
    s_waitcnt lgkmcnt(4)
    s_add_u32 m0, s48, 2048
    s_xor_b32 s49, s55, 40960
    buffer_load_dwordx4 v3, s[32:35], s49 offen lds
    v_mfma_f32_16x16x32_bf16 v[168:171], v[208:211], v[244:247], v[168:171]
    ds_read_b128 v[240:243], v14 offset:0
    v_fma_f32 v120, v120, s54, -v18
    v_fma_f32 v121, v121, s54, -v18
    v_fma_f32 v122, v122, s54, -v18
    v_mfma_f32_16x16x32_bf16 v[188:191], v[216:219], v[244:247], v[188:191]
    v_fma_f32 v123, v123, s54, -v18
    v_fma_f32 v140, v140, s54, -v18
    v_fma_f32 v141, v141, s54, -v18
    s_add_u32 m0, s48, 3072
    s_xor_b32 s49, s55, 45056
    buffer_load_dwordx4 v3, s[32:35], s49 offen lds
    v_mfma_f32_16x16x32_bf16 v[152:155], v[212:215], v[248:251], v[152:155]
    ds_read_b128 v[244:247], v14 offset:1024
    v_fma_f32 v142, v142, s54, -v18
    v_fma_f32 v143, v143, s54, -v18
    v_exp_f32 v120, v120
    v_mfma_f32_16x16x32_bf16 v[172:175], v[220:223], v[248:251], v[172:175]
    v_exp_f32 v121, v121
    v_exp_f32 v122, v122
    v_exp_f32 v123, v123
    s_add_u32 m0, s48, 4096
    s_xor_b32 s49, s55, 32896
    buffer_load_dwordx4 v3, s[32:35], s49 offen lds
    s_waitcnt lgkmcnt(5)
    v_mfma_f32_16x16x32_bf16 v[156:159], v[212:215], v[224:227], v[156:159]
    ds_read_b128 v[248:251], v14 offset:2048
    v_exp_f32 v140, v140
    v_exp_f32 v141, v141
    v_exp_f32 v142, v142
    v_mfma_f32_16x16x32_bf16 v[176:179], v[220:223], v[224:227], v[176:179]
    v_exp_f32 v143, v143
    v_cvt_pk_bf16_f32 v40, v120, v121
    v_cvt_pk_bf16_f32 v41, v122, v123
    s_add_u32 m0, s48, 5120
    s_xor_b32 s49, s55, 36992
    buffer_load_dwordx4 v3, s[32:35], s49 offen lds
    s_waitcnt lgkmcnt(5)
    v_mfma_f32_16x16x32_bf16 v[160:163], v[212:215], v[228:231], v[160:163]
    ds_read_b128 v[224:227], v14 offset:3072
    v_cvt_pk_bf16_f32 v42, v140, v141
    v_cvt_pk_bf16_f32 v43, v142, v143
    v_add_f32 v120, v120, v121
    v_mfma_f32_16x16x32_bf16 v[180:183], v[220:223], v[228:231], v[180:183]
    v_add_f32 v122, v122, v123
    v_add_f32 v140, v140, v141
    v_add_f32 v142, v142, v143
    s_waitcnt lgkmcnt(5)
    v_mfma_f32_16x16x32_bf16 v[164:167], v[212:215], v[232:235], v[164:167]
    ds_read_b128 v[228:231], v14 offset:4096
    v_add_f32 v120, v120, v122
    v_add_f32 v140, v140, v142
    v_add_f32 v23, v120, v140
    v_mfma_f32_16x16x32_bf16 v[184:187], v[220:223], v[232:235], v[184:187]
    v_max3_f32 v254, v124, v125, v126
    v_max3_f32 v255, v127, v144, v145
    v_max3_f32 v254, v254, v146, v147
    s_waitcnt lgkmcnt(5)
    v_mfma_f32_16x16x32_bf16 v[168:171], v[212:215], v[236:239], v[168:171]
    ds_read_b128 v[232:235], v14 offset:40960
    v_max_f32 v254, v254, v255
    v_mul_f32 v254, s54, v254
    v_ceil_f32 v19, v254
    v_mfma_f32_16x16x32_bf16 v[188:191], v[220:223], v[236:239], v[188:191]
    v_fma_f32 v124, v124, s54, -v19
    v_fma_f32 v125, v125, s54, -v19
    v_fma_f32 v126, v126, s54, -v19
    s_waitcnt vmcnt(6)
    ds_read_b128 v[208:211], v5 offset:6144
    ds_read_b128 v[212:215], v6 offset:6144
    ds_read_b128 v[216:219], v5 offset:8192
    ds_read_b128 v[220:223], v6 offset:8192
    s_waitcnt lgkmcnt(9)
    v_mfma_f32_16x16x32_bf16 v[152:155], v[192:195], v[240:243], v[152:155]
    ds_read_b128 v[236:239], v14 offset:41984
    v_fma_f32 v127, v127, s54, -v19
    v_fma_f32 v144, v144, s54, -v19
    v_fma_f32 v145, v145, s54, -v19
    v_mfma_f32_16x16x32_bf16 v[172:175], v[200:203], v[240:243], v[172:175]
    v_fma_f32 v146, v146, s54, -v19
    v_fma_f32 v147, v147, s54, -v19
    v_exp_f32 v124, v124
    s_waitcnt lgkmcnt(9)
    v_mfma_f32_16x16x32_bf16 v[156:159], v[192:195], v[244:247], v[156:159]
    ds_read_b128 v[240:243], v14 offset:43008
    v_exp_f32 v125, v125
    v_exp_f32 v126, v126
    v_exp_f32 v127, v127
    v_mfma_f32_16x16x32_bf16 v[176:179], v[200:203], v[244:247], v[176:179]
    v_exp_f32 v144, v144
    v_exp_f32 v145, v145
    v_exp_f32 v146, v146
    s_waitcnt lgkmcnt(9)
    v_mfma_f32_16x16x32_bf16 v[160:163], v[192:195], v[248:251], v[160:163]
    ds_read_b128 v[244:247], v14 offset:44032
    v_exp_f32 v147, v147
    v_cvt_pk_bf16_f32 v44, v124, v125
    v_cvt_pk_bf16_f32 v45, v126, v127
    v_mfma_f32_16x16x32_bf16 v[180:183], v[200:203], v[248:251], v[180:183]
    v_cvt_pk_bf16_f32 v46, v144, v145
    v_cvt_pk_bf16_f32 v47, v146, v147
    v_add_f32 v124, v124, v125
    s_waitcnt lgkmcnt(9)
    v_mfma_f32_16x16x32_bf16 v[164:167], v[192:195], v[224:227], v[164:167]
    ds_read_b128 v[248:251], v14 offset:45056
    v_add_f32 v126, v126, v127
    v_add_f32 v144, v144, v145
    v_add_f32 v146, v146, v147
    v_mfma_f32_16x16x32_bf16 v[184:187], v[200:203], v[224:227], v[184:187]
    v_add_f32 v124, v124, v126
    v_add_f32 v144, v144, v146
    v_add_f32 v24, v124, v144
    s_waitcnt lgkmcnt(4)
    s_add_u32 m0, s48, 6144
    s_xor_b32 s49, s55, 41088
    buffer_load_dwordx4 v3, s[32:35], s49 offen lds
    v_mfma_f32_16x16x32_bf16 v[168:171], v[192:195], v[228:231], v[168:171]
    ds_read_b128 v[224:227], v15 offset:0
    v_max3_f32 v252, v128, v129, v130
    v_max3_f32 v253, v131, v148, v149
    v_max3_f32 v252, v252, v150, v151
    v_mfma_f32_16x16x32_bf16 v[188:191], v[200:203], v[228:231], v[188:191]
    v_max_f32 v252, v252, v253
    v_mul_f32 v252, s54, v252
    v_ceil_f32 v20, v252
    s_add_u32 m0, s48, 7168
    s_xor_b32 s49, s55, 45184
    buffer_load_dwordx4 v3, s[32:35], s49 offen lds
    v_mfma_f32_16x16x32_bf16 v[152:155], v[196:199], v[232:235], v[152:155]
    ds_read_b128 v[228:231], v15 offset:1024
    v_fma_f32 v128, v128, s54, -v20
    v_fma_f32 v129, v129, s54, -v20
    v_fma_f32 v130, v130, s54, -v20
    v_mfma_f32_16x16x32_bf16 v[172:175], v[204:207], v[232:235], v[172:175]
    v_fma_f32 v131, v131, s54, -v20
    v_fma_f32 v148, v148, s54, -v20
    v_fma_f32 v149, v149, s54, -v20
    s_add_u32 m0, s48, 8192
    s_xor_b32 s49, s55, 33024
    buffer_load_dwordx4 v3, s[32:35], s49 offen lds
    s_waitcnt lgkmcnt(5)
    v_mfma_f32_16x16x32_bf16 v[156:159], v[196:199], v[236:239], v[156:159]
    ds_read_b128 v[232:235], v15 offset:2048
    v_fma_f32 v150, v150, s54, -v20
    v_fma_f32 v151, v151, s54, -v20
    v_exp_f32 v128, v128
    v_mfma_f32_16x16x32_bf16 v[176:179], v[204:207], v[236:239], v[176:179]
    v_exp_f32 v129, v129
    v_exp_f32 v130, v130
    v_exp_f32 v131, v131
    s_add_u32 m0, s48, 9216
    s_xor_b32 s49, s55, 37120
    buffer_load_dwordx4 v3, s[32:35], s49 offen lds
    s_waitcnt lgkmcnt(5)
    v_mfma_f32_16x16x32_bf16 v[160:163], v[196:199], v[240:243], v[160:163]
    ds_read_b128 v[236:239], v15 offset:3072
    v_exp_f32 v148, v148
    v_exp_f32 v149, v149
    v_exp_f32 v150, v150
    v_mfma_f32_16x16x32_bf16 v[180:183], v[204:207], v[240:243], v[180:183]
    v_exp_f32 v151, v151
    v_cvt_pk_bf16_f32 v48, v128, v129
    v_cvt_pk_bf16_f32 v49, v130, v131
    s_waitcnt lgkmcnt(5)
    v_mfma_f32_16x16x32_bf16 v[164:167], v[196:199], v[244:247], v[164:167]
    ds_read_b128 v[240:243], v15 offset:4096
    v_cvt_pk_bf16_f32 v50, v148, v149
    v_cvt_pk_bf16_f32 v51, v150, v151
    v_add_f32 v128, v128, v129
    v_mfma_f32_16x16x32_bf16 v[184:187], v[204:207], v[244:247], v[184:187]
    v_add_f32 v130, v130, v131
    v_add_f32 v148, v148, v149
    v_add_f32 v150, v150, v151
    s_waitcnt lgkmcnt(5)
    v_mfma_f32_16x16x32_bf16 v[168:171], v[196:199], v[248:251], v[168:171]
    ds_read_b128 v[244:247], v15 offset:40960
    v_add_f32 v128, v128, v130
    v_add_f32 v148, v148, v150
    v_add_f32 v25, v128, v148
    v_mfma_f32_16x16x32_bf16 v[188:191], v[204:207], v[248:251], v[188:191]
    s_waitcnt vmcnt(6)
    ds_read_b128 v[192:195], v5 offset:0
    ds_read_b128 v[196:199], v6 offset:0
    ds_read_b128 v[200:203], v5 offset:2048
    ds_read_b128 v[204:207], v6 offset:2048
    s_waitcnt lgkmcnt(9)
    v_mfma_f32_16x16x32_bf16 v[152:155], v[208:211], v[224:227], v[152:155]
    ds_read_b128 v[248:251], v15 offset:41984
    v_mfma_f32_16x16x32_bf16 v[172:175], v[216:219], v[224:227], v[172:175]
    s_waitcnt lgkmcnt(9)
    v_mfma_f32_16x16x32_bf16 v[156:159], v[208:211], v[228:231], v[156:159]
    ds_read_b128 v[224:227], v15 offset:43008
    v_mfma_f32_16x16x32_bf16 v[176:179], v[216:219], v[228:231], v[176:179]
    s_waitcnt lgkmcnt(9)
    v_mfma_f32_16x16x32_bf16 v[160:163], v[208:211], v[232:235], v[160:163]
    ds_read_b128 v[228:231], v15 offset:44032
    v_mfma_f32_16x16x32_bf16 v[180:183], v[216:219], v[232:235], v[180:183]
    s_waitcnt lgkmcnt(9)
    v_mfma_f32_16x16x32_bf16 v[164:167], v[208:211], v[236:239], v[164:167]
    ds_read_b128 v[232:235], v15 offset:45056
    v_mfma_f32_16x16x32_bf16 v[184:187], v[216:219], v[236:239], v[184:187]
    s_waitcnt lgkmcnt(4)
    s_add_u32 m0, s48, 0
    s_xor_b32 s49, s55, 41216
    buffer_load_dwordx4 v3, s[32:35], s49 offen lds
    v_mfma_f32_16x16x32_bf16 v[168:171], v[208:211], v[240:243], v[168:171]
    ds_read_b128 v[236:239], v2 offset:0
    v_mfma_f32_16x16x32_bf16 v[188:191], v[216:219], v[240:243], v[188:191]
    s_add_u32 m0, s48, 1024
    s_xor_b32 s49, s55, 45312
    buffer_load_dwordx4 v3, s[32:35], s49 offen lds
    v_mfma_f32_16x16x32_bf16 v[152:155], v[212:215], v[244:247], v[152:155]
    ds_read_b128 v[240:243], v2 offset:1024
    v_mfma_f32_16x16x32_bf16 v[172:175], v[220:223], v[244:247], v[172:175]
    s_add_u32 m0, s48, 2048
    s_xor_b32 s49, s55, 33152
    buffer_load_dwordx4 v3, s[32:35], s49 offen lds
    s_waitcnt lgkmcnt(5)
    v_mfma_f32_16x16x32_bf16 v[156:159], v[212:215], v[248:251], v[156:159]
    ds_read_b128 v[244:247], v2 offset:2048
    v_mfma_f32_16x16x32_bf16 v[176:179], v[220:223], v[248:251], v[176:179]
    s_add_u32 m0, s48, 3072
    s_xor_b32 s49, s55, 37248
    buffer_load_dwordx4 v3, s[32:35], s49 offen lds
    s_waitcnt lgkmcnt(5)
    v_mfma_f32_16x16x32_bf16 v[160:163], v[212:215], v[224:227], v[160:163]
    ds_read_b128 v[248:251], v2 offset:3072
    v_mfma_f32_16x16x32_bf16 v[180:183], v[220:223], v[224:227], v[180:183]
    s_waitcnt lgkmcnt(5)
    v_mfma_f32_16x16x32_bf16 v[164:167], v[212:215], v[228:231], v[164:167]
    ds_read_b128 v[224:227], v2 offset:4096
    v_mfma_f32_16x16x32_bf16 v[184:187], v[220:223], v[228:231], v[184:187]
    s_waitcnt lgkmcnt(5)
    v_mfma_f32_16x16x32_bf16 v[168:171], v[212:215], v[232:235], v[168:171]
    ds_read_b128 v[228:231], v2 offset:40960
    v_mfma_f32_16x16x32_bf16 v[188:191], v[220:223], v[232:235], v[188:191]
    s_barrier
    s_waitcnt vmcnt(6)
    ds_read_b128 v[208:211], v5 offset:4096
    ds_read_b128 v[212:215], v6 offset:4096
    ds_read_b128 v[216:219], v5 offset:6144
    ds_read_b128 v[220:223], v6 offset:6144
    s_waitcnt lgkmcnt(9)
    v_mfma_f32_16x16x32_bf16 v[112:115], v[192:195], v[236:239], 0
    ds_read_b128 v[232:235], v2 offset:41984
    v_mfma_f32_16x16x32_bf16 v[132:135], v[200:203], v[236:239], 0
    s_waitcnt lgkmcnt(9)
    v_mfma_f32_16x16x32_bf16 v[116:119], v[192:195], v[240:243], 0
    ds_read_b128 v[236:239], v2 offset:43008
    v_mfma_f32_16x16x32_bf16 v[136:139], v[200:203], v[240:243], 0
    s_waitcnt lgkmcnt(9)
    v_mfma_f32_16x16x32_bf16 v[120:123], v[192:195], v[244:247], 0
    ds_read_b128 v[240:243], v2 offset:44032
    v_max3_f32 v252, v152, v153, v154
    v_max3_f32 v253, v155, v172, v173
    v_max3_f32 v252, v252, v174, v175
    v_mfma_f32_16x16x32_bf16 v[140:143], v[200:203], v[244:247], 0
    v_max_f32 v252, v252, v253
    v_mul_f32 v252, s54, v252
    v_ceil_f32 v252, v252
    s_waitcnt lgkmcnt(9)
    v_mfma_f32_16x16x32_bf16 v[124:127], v[192:195], v[248:251], 0
    ds_read_b128 v[244:247], v2 offset:45056
    v_max_f32 v252, v252, v16
    v_sub_f32 v253, v16, v252
    v_mov_b32 v16, v252
    v_mfma_f32_16x16x32_bf16 v[144:147], v[200:203], v[248:251], 0
    v_max_f32 v253, 0xc37f0000, v253
    v_cvt_i32_f32 v253, v253
    v_ldexp_f32 v21, v21, v253
    s_waitcnt lgkmcnt(4)
    s_add_u32 m0, s48, 4096
    s_xor_b32 s49, s55, 41344
    buffer_load_dwordx4 v3, s[32:35], s49 offen lds
    v_mfma_f32_16x16x32_bf16 v[128:131], v[192:195], v[224:227], 0
    ds_read_b128 v[248:251], v12 offset:0
    v_sub_u32 v26, 0, v253
    v_fma_f32 v152, v152, s54, -v16
    v_fma_f32 v153, v153, s54, -v16
    v_mfma_f32_16x16x32_bf16 v[148:151], v[200:203], v[224:227], 0
    v_fma_f32 v154, v154, s54, -v16
    v_fma_f32 v155, v155, s54, -v16
    v_fma_f32 v172, v172, s54, -v16
    s_add_u32 m0, s48, 5120
    s_xor_b32 s49, s55, 45440
    buffer_load_dwordx4 v3, s[32:35], s49 offen lds
    v_mfma_f32_16x16x32_bf16 v[112:115], v[196:199], v[228:231], v[112:115]
    ds_read_b128 v[224:227], v12 offset:1024
    v_fma_f32 v173, v173, s54, -v16
    v_fma_f32 v174, v174, s54, -v16
    v_fma_f32 v175, v175, s54, -v16
    v_mfma_f32_16x16x32_bf16 v[132:135], v[204:207], v[228:231], v[132:135]
    v_exp_f32 v152, v152
    v_exp_f32 v153, v153
    v_exp_f32 v154, v154
    s_add_u32 m0, s48, 6144
    s_xor_b32 s49, s55, 49152
    buffer_load_dwordx4 v3, s[32:35], s49 offen lds
    s_waitcnt lgkmcnt(5)
    v_mfma_f32_16x16x32_bf16 v[116:119], v[196:199], v[232:235], v[116:119]
    ds_read_b128 v[228:231], v12 offset:2048
    v_exp_f32 v155, v155
    v_exp_f32 v172, v172
    v_exp_f32 v173, v173
    v_mfma_f32_16x16x32_bf16 v[136:139], v[204:207], v[232:235], v[136:139]
    v_exp_f32 v174, v174
    v_exp_f32 v175, v175
    v_cvt_pk_bf16_f32 v52, v152, v153
    s_add_u32 m0, s48, 7168
    s_xor_b32 s49, s55, 53248
    buffer_load_dwordx4 v3, s[32:35], s49 offen lds
    s_waitcnt lgkmcnt(5)
    v_mfma_f32_16x16x32_bf16 v[120:123], v[196:199], v[236:239], v[120:123]
    ds_read_b128 v[232:235], v12 offset:3072
    v_cvt_pk_bf16_f32 v53, v154, v155
    v_cvt_pk_bf16_f32 v54, v172, v173
    v_cvt_pk_bf16_f32 v55, v174, v175
    v_mfma_f32_16x16x32_bf16 v[140:143], v[204:207], v[236:239], v[140:143]
    v_add_f32 v152, v152, v153
    v_add_f32 v154, v154, v155
    v_add_f32 v172, v172, v173
    s_waitcnt lgkmcnt(5)
    v_mfma_f32_16x16x32_bf16 v[124:127], v[196:199], v[240:243], v[124:127]
    ds_read_b128 v[236:239], v12 offset:4096
    v_add_f32 v174, v174, v175
    v_add_f32 v152, v152, v154
    v_add_f32 v172, v172, v174
    v_mfma_f32_16x16x32_bf16 v[144:147], v[204:207], v[240:243], v[144:147]
    v_add_f32 v152, v152, v172
    v_add_f32 v21, v21, v152
    v_max3_f32 v254, v156, v157, v158
    s_waitcnt lgkmcnt(5)
    v_mfma_f32_16x16x32_bf16 v[128:131], v[196:199], v[244:247], v[128:131]
    ds_read_b128 v[240:243], v12 offset:40960
    v_max3_f32 v255, v159, v176, v177
    v_max3_f32 v254, v254, v178, v179
    v_max_f32 v254, v254, v255
    v_mfma_f32_16x16x32_bf16 v[148:151], v[204:207], v[244:247], v[148:151]
    v_mul_f32 v254, s54, v254
    v_ceil_f32 v254, v254
    v_max_f32 v254, v254, v17
    s_waitcnt vmcnt(6)
    ds_read_b128 v[192:195], v5 offset:8192
    ds_read_b128 v[196:199], v6 offset:8192
    ds_read_b128 v[200:203], v5 offset:0
    ds_read_b128 v[204:207], v6 offset:0
    s_waitcnt lgkmcnt(9)
    v_mfma_f32_16x16x32_bf16 v[112:115], v[208:211], v[248:251], v[112:115]
    ds_read_b128 v[244:247], v12 offset:41984
    v_sub_f32 v255, v17, v254
    v_mov_b32 v17, v254
    v_max_f32 v255, 0xc37f0000, v255
    v_mfma_f32_16x16x32_bf16 v[132:135], v[216:219], v[248:251], v[132:135]
    v_cvt_i32_f32 v255, v255
    v_ldexp_f32 v22, v22, v255
    v_sub_u32 v27, 0, v255
    s_waitcnt lgkmcnt(9)
    v_mfma_f32_16x16x32_bf16 v[116:119], v[208:211], v[224:227], v[116:119]
    ds_read_b128 v[248:251], v12 offset:43008
    v_fma_f32 v156, v156, s54, -v17
    v_fma_f32 v157, v157, s54, -v17
    v_fma_f32 v158, v158, s54, -v17
    v_mfma_f32_16x16x32_bf16 v[136:139], v[216:219], v[224:227], v[136:139]
    v_fma_f32 v159, v159, s54, -v17
    v_fma_f32 v176, v176, s54, -v17
    v_fma_f32 v177, v177, s54, -v17
    s_waitcnt lgkmcnt(9)
    v_mfma_f32_16x16x32_bf16 v[120:123], v[208:211], v[228:231], v[120:123]
    ds_read_b128 v[224:227], v12 offset:44032
    v_fma_f32 v178, v178, s54, -v17
    v_fma_f32 v179, v179, s54, -v17
    v_exp_f32 v156, v156
    v_mfma_f32_16x16x32_bf16 v[140:143], v[216:219], v[228:231], v[140:143]
    v_exp_f32 v157, v157
    v_exp_f32 v158, v158
    v_exp_f32 v159, v159
    s_waitcnt lgkmcnt(9)
    v_mfma_f32_16x16x32_bf16 v[124:127], v[208:211], v[232:235], v[124:127]
    ds_read_b128 v[228:231], v12 offset:45056
    v_exp_f32 v176, v176
    v_exp_f32 v177, v177
    v_exp_f32 v178, v178
    v_mfma_f32_16x16x32_bf16 v[144:147], v[216:219], v[232:235], v[144:147]
    v_exp_f32 v179, v179
    v_cvt_pk_bf16_f32 v56, v156, v157
    v_cvt_pk_bf16_f32 v57, v158, v159
    s_waitcnt lgkmcnt(4)
    s_add_u32 m0, s48, 8192
    s_xor_b32 s49, s55, 57344
    buffer_load_dwordx4 v3, s[32:35], s49 offen lds
    v_mfma_f32_16x16x32_bf16 v[128:131], v[208:211], v[236:239], v[128:131]
    ds_read_b128 v[232:235], v14 offset:0
    v_cvt_pk_bf16_f32 v58, v176, v177
    v_cvt_pk_bf16_f32 v59, v178, v179
    v_add_f32 v156, v156, v157
    v_mfma_f32_16x16x32_bf16 v[148:151], v[216:219], v[236:239], v[148:151]
    v_add_f32 v158, v158, v159
    v_add_f32 v176, v176, v177
    v_add_f32 v178, v178, v179
    s_add_u32 m0, s48, 9216
    s_xor_b32 s49, s55, 61440
    buffer_load_dwordx4 v3, s[32:35], s49 offen lds
    v_mfma_f32_16x16x32_bf16 v[112:115], v[212:215], v[240:243], v[112:115]
    ds_read_b128 v[236:239], v14 offset:1024
    v_add_f32 v156, v156, v158
    v_add_f32 v176, v176, v178
    v_add_f32 v156, v156, v176
    v_mfma_f32_16x16x32_bf16 v[132:135], v[220:223], v[240:243], v[132:135]
    v_add_f32 v22, v22, v156
    v_max3_f32 v252, v160, v161, v162
    v_max3_f32 v253, v163, v180, v181
    s_add_u32 m0, s48, 0
    s_xor_b32 s49, s55, 49280
    buffer_load_dwordx4 v3, s[32:35], s49 offen lds
    s_waitcnt lgkmcnt(5)
    v_mfma_f32_16x16x32_bf16 v[116:119], v[212:215], v[244:247], v[116:119]
    ds_read_b128 v[240:243], v14 offset:2048
    v_max3_f32 v252, v252, v182, v183
    v_max_f32 v252, v252, v253
    v_mul_f32 v252, s54, v252
    v_mfma_f32_16x16x32_bf16 v[136:139], v[220:223], v[244:247], v[136:139]
    v_ceil_f32 v252, v252
    v_max_f32 v252, v252, v18
    v_sub_f32 v253, v18, v252
    s_add_u32 m0, s48, 1024
    s_xor_b32 s49, s55, 53376
    buffer_load_dwordx4 v3, s[32:35], s49 offen lds
    s_waitcnt lgkmcnt(5)
    v_mfma_f32_16x16x32_bf16 v[120:123], v[212:215], v[248:251], v[120:123]
    ds_read_b128 v[244:247], v14 offset:3072
    v_mov_b32 v18, v252
    v_max_f32 v253, 0xc37f0000, v253
    v_cvt_i32_f32 v253, v253
    v_mfma_f32_16x16x32_bf16 v[140:143], v[220:223], v[248:251], v[140:143]
    v_ldexp_f32 v23, v23, v253
    v_sub_u32 v28, 0, v253
    v_fma_f32 v160, v160, s54, -v18
    s_waitcnt lgkmcnt(5)
    v_mfma_f32_16x16x32_bf16 v[124:127], v[212:215], v[224:227], v[124:127]
    ds_read_b128 v[248:251], v14 offset:4096
    v_fma_f32 v161, v161, s54, -v18
    v_fma_f32 v162, v162, s54, -v18
    v_fma_f32 v163, v163, s54, -v18
    v_mfma_f32_16x16x32_bf16 v[144:147], v[220:223], v[224:227], v[144:147]
    v_fma_f32 v180, v180, s54, -v18
    v_fma_f32 v181, v181, s54, -v18
    v_fma_f32 v182, v182, s54, -v18
    s_waitcnt lgkmcnt(5)
    v_mfma_f32_16x16x32_bf16 v[128:131], v[212:215], v[228:231], v[128:131]
    ds_read_b128 v[224:227], v14 offset:40960
    v_fma_f32 v183, v183, s54, -v18
    v_exp_f32 v160, v160
    v_exp_f32 v161, v161
    v_mfma_f32_16x16x32_bf16 v[148:151], v[220:223], v[228:231], v[148:151]
    v_exp_f32 v162, v162
    v_exp_f32 v163, v163
    v_exp_f32 v180, v180
    s_waitcnt vmcnt(6)
    ds_read_b128 v[208:211], v5 offset:2048
    ds_read_b128 v[212:215], v6 offset:2048
    ds_read_b128 v[216:219], v5 offset:4096
    ds_read_b128 v[220:223], v6 offset:4096
    s_waitcnt lgkmcnt(9)
    v_mfma_f32_16x16x32_bf16 v[112:115], v[192:195], v[232:235], v[112:115]
    ds_read_b128 v[228:231], v14 offset:41984
    v_exp_f32 v181, v181
    v_exp_f32 v182, v182
    v_exp_f32 v183, v183
    v_mfma_f32_16x16x32_bf16 v[132:135], v[200:203], v[232:235], v[132:135]
    v_cvt_pk_bf16_f32 v60, v160, v161
    v_cvt_pk_bf16_f32 v61, v162, v163
    v_cvt_pk_bf16_f32 v62, v180, v181
    s_waitcnt lgkmcnt(9)
    v_mfma_f32_16x16x32_bf16 v[116:119], v[192:195], v[236:239], v[116:119]
    ds_read_b128 v[232:235], v14 offset:43008
    v_cvt_pk_bf16_f32 v63, v182, v183
    v_add_f32 v160, v160, v161
    v_add_f32 v162, v162, v163
    v_mfma_f32_16x16x32_bf16 v[136:139], v[200:203], v[236:239], v[136:139]
    v_add_f32 v180, v180, v181
    v_add_f32 v182, v182, v183
    v_add_f32 v160, v160, v162
    s_waitcnt lgkmcnt(9)
    v_mfma_f32_16x16x32_bf16 v[120:123], v[192:195], v[240:243], v[120:123]
    ds_read_b128 v[236:239], v14 offset:44032
    v_add_f32 v180, v180, v182
    v_add_f32 v160, v160, v180
    v_add_f32 v23, v23, v160
    v_mfma_f32_16x16x32_bf16 v[140:143], v[200:203], v[240:243], v[140:143]
    v_max3_f32 v254, v164, v165, v166
    v_max3_f32 v255, v167, v184, v185
    v_max3_f32 v254, v254, v186, v187
    s_waitcnt lgkmcnt(9)
    v_mfma_f32_16x16x32_bf16 v[124:127], v[192:195], v[244:247], v[124:127]
    ds_read_b128 v[240:243], v14 offset:45056
    v_max_f32 v254, v254, v255
    v_mul_f32 v254, s54, v254
    v_ceil_f32 v254, v254
    v_mfma_f32_16x16x32_bf16 v[144:147], v[200:203], v[244:247], v[144:147]
    v_max_f32 v254, v254, v19
    v_sub_f32 v255, v19, v254
    v_mov_b32 v19, v254
    s_waitcnt lgkmcnt(4)
    s_add_u32 m0, s48, 2048
    s_xor_b32 s49, s55, 57472
    buffer_load_dwordx4 v3, s[32:35], s49 offen lds
    v_mfma_f32_16x16x32_bf16 v[128:131], v[192:195], v[248:251], v[128:131]
    ds_read_b128 v[244:247], v15 offset:0
    v_max_f32 v255, 0xc37f0000, v255
    v_cvt_i32_f32 v255, v255
    v_ldexp_f32 v24, v24, v255
    v_mfma_f32_16x16x32_bf16 v[148:151], v[200:203], v[248:251], v[148:151]
    v_sub_u32 v29, 0, v255
    v_fma_f32 v164, v164, s54, -v19
    v_fma_f32 v165, v165, s54, -v19
    s_add_u32 m0, s48, 3072
    s_xor_b32 s49, s55, 61568
    buffer_load_dwordx4 v3, s[32:35], s49 offen lds
    v_mfma_f32_16x16x32_bf16 v[112:115], v[196:199], v[224:227], v[112:115]
    ds_read_b128 v[248:251], v15 offset:1024
    v_fma_f32 v166, v166, s54, -v19
    v_fma_f32 v167, v167, s54, -v19
    v_fma_f32 v184, v184, s54, -v19
    v_mfma_f32_16x16x32_bf16 v[132:135], v[204:207], v[224:227], v[132:135]
    v_fma_f32 v185, v185, s54, -v19
    v_fma_f32 v186, v186, s54, -v19
    v_fma_f32 v187, v187, s54, -v19
    s_add_u32 m0, s48, 4096
    s_xor_b32 s49, s55, 49408
    buffer_load_dwordx4 v3, s[32:35], s49 offen lds
    s_waitcnt lgkmcnt(5)
    v_mfma_f32_16x16x32_bf16 v[116:119], v[196:199], v[228:231], v[116:119]
    ds_read_b128 v[224:227], v15 offset:2048
    v_exp_f32 v164, v164
    v_exp_f32 v165, v165
    v_exp_f32 v166, v166
    v_mfma_f32_16x16x32_bf16 v[136:139], v[204:207], v[228:231], v[136:139]
    v_exp_f32 v167, v167
    v_exp_f32 v184, v184
    v_exp_f32 v185, v185
    s_add_u32 m0, s48, 5120
    s_xor_b32 s49, s55, 53504
    buffer_load_dwordx4 v3, s[32:35], s49 offen lds
    s_waitcnt lgkmcnt(5)
    v_mfma_f32_16x16x32_bf16 v[120:123], v[196:199], v[232:235], v[120:123]
    ds_read_b128 v[228:231], v15 offset:3072
    v_exp_f32 v186, v186
    v_exp_f32 v187, v187
    v_cvt_pk_bf16_f32 v64, v164, v165
    v_mfma_f32_16x16x32_bf16 v[140:143], v[204:207], v[232:235], v[140:143]
    v_cvt_pk_bf16_f32 v65, v166, v167
    v_cvt_pk_bf16_f32 v66, v184, v185
    v_cvt_pk_bf16_f32 v67, v186, v187
    s_waitcnt lgkmcnt(5)
    v_mfma_f32_16x16x32_bf16 v[124:127], v[196:199], v[236:239], v[124:127]
    ds_read_b128 v[232:235], v15 offset:4096
    v_add_f32 v164, v164, v165
    v_add_f32 v166, v166, v167
    v_add_f32 v184, v184, v185
    v_mfma_f32_16x16x32_bf16 v[144:147], v[204:207], v[236:239], v[144:147]
    v_add_f32 v186, v186, v187
    v_add_f32 v164, v164, v166
    v_add_f32 v184, v184, v186
    s_waitcnt lgkmcnt(5)
    v_mfma_f32_16x16x32_bf16 v[128:131], v[196:199], v[240:243], v[128:131]
    ds_read_b128 v[236:239], v15 offset:40960
    v_add_f32 v164, v164, v184
    v_add_f32 v24, v24, v164
    v_max3_f32 v252, v168, v169, v170
    v_mfma_f32_16x16x32_bf16 v[148:151], v[204:207], v[240:243], v[148:151]
    v_max3_f32 v253, v171, v188, v189
    v_max3_f32 v252, v252, v190, v191
    v_max_f32 v252, v252, v253
    s_waitcnt vmcnt(6)
    ds_read_b128 v[192:195], v5 offset:6144
    ds_read_b128 v[196:199], v6 offset:6144
    ds_read_b128 v[200:203], v5 offset:8192
    ds_read_b128 v[204:207], v6 offset:8192
    s_waitcnt lgkmcnt(9)
    v_mfma_f32_16x16x32_bf16 v[112:115], v[208:211], v[244:247], v[112:115]
    ds_read_b128 v[240:243], v15 offset:41984
    v_mul_f32 v252, s54, v252
    v_ceil_f32 v252, v252
    v_max_f32 v252, v252, v20
    v_mfma_f32_16x16x32_bf16 v[132:135], v[216:219], v[244:247], v[132:135]
    v_sub_f32 v253, v20, v252
    v_mov_b32 v20, v252
    v_max_f32 v253, 0xc37f0000, v253
    s_waitcnt lgkmcnt(9)
    v_mfma_f32_16x16x32_bf16 v[116:119], v[208:211], v[248:251], v[116:119]
    ds_read_b128 v[244:247], v15 offset:43008
    v_cvt_i32_f32 v253, v253
    v_ldexp_f32 v25, v25, v253
    v_sub_u32 v30, 0, v253
    v_mfma_f32_16x16x32_bf16 v[136:139], v[216:219], v[248:251], v[136:139]
    v_fma_f32 v168, v168, s54, -v20
    v_fma_f32 v169, v169, s54, -v20
    v_fma_f32 v170, v170, s54, -v20
    s_waitcnt lgkmcnt(9)
    v_mfma_f32_16x16x32_bf16 v[120:123], v[208:211], v[224:227], v[120:123]
    ds_read_b128 v[248:251], v15 offset:44032
    v_fma_f32 v171, v171, s54, -v20
    v_fma_f32 v188, v188, s54, -v20
    v_fma_f32 v189, v189, s54, -v20
    v_mfma_f32_16x16x32_bf16 v[140:143], v[216:219], v[224:227], v[140:143]
    v_fma_f32 v190, v190, s54, -v20
    v_fma_f32 v191, v191, s54, -v20
    v_exp_f32 v168, v168
    s_waitcnt lgkmcnt(9)
    v_mfma_f32_16x16x32_bf16 v[124:127], v[208:211], v[228:231], v[124:127]
    ds_read_b128 v[224:227], v15 offset:45056
    v_exp_f32 v169, v169
    v_exp_f32 v170, v170
    v_exp_f32 v171, v171
    v_mfma_f32_16x16x32_bf16 v[144:147], v[216:219], v[228:231], v[144:147]
    v_exp_f32 v188, v188
    v_exp_f32 v189, v189
    v_exp_f32 v190, v190
    s_waitcnt lgkmcnt(4)
    s_add_u32 m0, s48, 6144
    s_xor_b32 s49, s55, 57600
    buffer_load_dwordx4 v3, s[32:35], s49 offen lds
    v_mfma_f32_16x16x32_bf16 v[128:131], v[208:211], v[232:235], v[128:131]
    ds_read_b128 v[228:231], v2 offset:0
    v_exp_f32 v191, v191
    v_cvt_pk_bf16_f32 v68, v168, v169
    v_cvt_pk_bf16_f32 v69, v170, v171
    v_mfma_f32_16x16x32_bf16 v[148:151], v[216:219], v[232:235], v[148:151]
    v_cvt_pk_bf16_f32 v70, v188, v189
    v_cvt_pk_bf16_f32 v71, v190, v191
    v_add_f32 v168, v168, v169
    s_add_u32 m0, s48, 7168
    s_xor_b32 s49, s55, 61696
    buffer_load_dwordx4 v3, s[32:35], s49 offen lds
    v_mfma_f32_16x16x32_bf16 v[112:115], v[212:215], v[236:239], v[112:115]
    ds_read_b128 v[232:235], v2 offset:1024
    v_add_f32 v170, v170, v171
    v_add_f32 v188, v188, v189
    v_add_f32 v190, v190, v191
    v_mfma_f32_16x16x32_bf16 v[132:135], v[220:223], v[236:239], v[132:135]
    v_add_f32 v168, v168, v170
    v_add_f32 v188, v188, v190
    v_add_f32 v168, v168, v188
    s_add_u32 m0, s48, 8192
    s_xor_b32 s49, s55, 49536
    buffer_load_dwordx4 v3, s[32:35], s49 offen lds
    s_waitcnt lgkmcnt(5)
    v_mfma_f32_16x16x32_bf16 v[116:119], v[212:215], v[240:243], v[116:119]
    ds_read_b128 v[236:239], v2 offset:2048
    v_add_f32 v25, v25, v168
    v_mfma_f32_16x16x32_bf16 v[136:139], v[220:223], v[240:243], v[136:139]
    s_add_u32 m0, s48, 9216
    s_xor_b32 s49, s55, 53632
    buffer_load_dwordx4 v3, s[32:35], s49 offen lds
    s_waitcnt lgkmcnt(5)
    v_mfma_f32_16x16x32_bf16 v[120:123], v[212:215], v[244:247], v[120:123]
    ds_read_b128 v[240:243], v2 offset:3072
    v_mfma_f32_16x16x32_bf16 v[140:143], v[220:223], v[244:247], v[140:143]
    s_waitcnt lgkmcnt(5)
    v_mfma_f32_16x16x32_bf16 v[124:127], v[212:215], v[248:251], v[124:127]
    ds_read_b128 v[244:247], v2 offset:4096
    v_mfma_f32_16x16x32_bf16 v[144:147], v[220:223], v[248:251], v[144:147]
    s_waitcnt lgkmcnt(5)
    v_mfma_f32_16x16x32_bf16 v[128:131], v[212:215], v[224:227], v[128:131]
    ds_read_b128 v[248:251], v2 offset:40960
    v_mfma_f32_16x16x32_bf16 v[148:151], v[220:223], v[224:227], v[148:151]
    s_barrier
    s_waitcnt vmcnt(6)
    ds_read_b128 v[208:211], v5 offset:0
    ds_read_b128 v[212:215], v6 offset:0
    ds_read_b128 v[216:219], v5 offset:2048
    ds_read_b128 v[220:223], v6 offset:2048
    s_waitcnt lgkmcnt(9)
    v_mfma_f32_16x16x32_bf16 v[152:155], v[192:195], v[228:231], 0
    ds_read_b128 v[224:227], v2 offset:41984
    v_mfma_f32_16x16x32_bf16 v[172:175], v[200:203], v[228:231], 0
    s_waitcnt lgkmcnt(9)
    v_mfma_f32_16x16x32_bf16 v[156:159], v[192:195], v[232:235], 0
    ds_read_b128 v[228:231], v2 offset:43008
    v_mfma_f32_16x16x32_bf16 v[176:179], v[200:203], v[232:235], 0
    s_waitcnt lgkmcnt(9)
    v_mfma_f32_16x16x32_bf16 v[160:163], v[192:195], v[236:239], 0
    ds_read_b128 v[232:235], v2 offset:44032
    v_max_f32 v252, v112, v113
    v_max3_f32 v252, v114, v115, v252
    v_max3_f32 v252, v132, v133, v252
    v_mfma_f32_16x16x32_bf16 v[180:183], v[200:203], v[236:239], 0
    v_max3_f32 v252, v134, v135, v252
    v_cvt_pk_bf16_f32 v72, v112, v113
    v_cvt_pk_bf16_f32 v73, v114, v115
    s_waitcnt lgkmcnt(9)
    v_mfma_f32_16x16x32_bf16 v[164:167], v[192:195], v[240:243], 0
    ds_read_b128 v[236:239], v2 offset:45056
    v_cvt_pk_bf16_f32 v74, v132, v133
    v_cvt_pk_bf16_f32 v75, v134, v135
    v_max_f32 v253, v116, v117
    v_mfma_f32_16x16x32_bf16 v[184:187], v[200:203], v[240:243], 0
    v_max3_f32 v253, v118, v119, v253
    v_max3_f32 v253, v136, v137, v253
    v_max3_f32 v253, v138, v139, v253
    s_waitcnt lgkmcnt(4)
    s_add_u32 m0, s48, 0
    s_xor_b32 s49, s55, 57728
    buffer_load_dwordx4 v3, s[32:35], s49 offen lds
    v_mfma_f32_16x16x32_bf16 v[168:171], v[192:195], v[244:247], 0
    ds_read_b128 v[240:243], v12 offset:0
    v_cvt_pk_bf16_f32 v76, v116, v117
    v_cvt_pk_bf16_f32 v77, v118, v119
    v_cvt_pk_bf16_f32 v78, v136, v137
    v_mfma_f32_16x16x32_bf16 v[188:191], v[200:203], v[244:247], 0
    v_cvt_pk_bf16_f32 v79, v138, v139
    v_max_f32 v254, v120, v121
    v_max3_f32 v254, v122, v123, v254
    s_add_u32 m0, s48, 1024
    s_xor_b32 s49, s55, 61824
    buffer_load_dwordx4 v3, s[32:35], s49 offen lds
    v_mfma_f32_16x16x32_bf16 v[152:155], v[196:199], v[248:251], v[152:155]
    ds_read_b128 v[244:247], v12 offset:1024
    v_max3_f32 v254, v140, v141, v254
    v_max3_f32 v254, v142, v143, v254
    v_cvt_pk_bf16_f32 v80, v120, v121
    v_mfma_f32_16x16x32_bf16 v[172:175], v[204:207], v[248:251], v[172:175]
    v_cvt_pk_bf16_f32 v81, v122, v123
    v_cvt_pk_bf16_f32 v82, v140, v141
    v_cvt_pk_bf16_f32 v83, v142, v143
    s_add_u32 m0, s48, 2048
    s_xor_b32 s49, s28, 0
    buffer_load_dwordx4 v3, s[36:39], s49 offen nt lds
    s_waitcnt lgkmcnt(5)
    v_mfma_f32_16x16x32_bf16 v[156:159], v[196:199], v[224:227], v[156:159]
    ds_read_b128 v[248:251], v12 offset:2048
    v_max_f32 v255, v124, v125
    v_max3_f32 v255, v126, v127, v255
    v_max3_f32 v255, v144, v145, v255
    v_mfma_f32_16x16x32_bf16 v[176:179], v[204:207], v[224:227], v[176:179]
    v_max3_f32 v255, v146, v147, v255
    v_cvt_pk_bf16_f32 v84, v124, v125
    v_cvt_pk_bf16_f32 v85, v126, v127
    s_add_u32 m0, s48, 3072
    s_xor_b32 s49, s28, 4096
    buffer_load_dwordx4 v3, s[36:39], s49 offen nt lds
    s_waitcnt lgkmcnt(5)
    v_mfma_f32_16x16x32_bf16 v[160:163], v[196:199], v[228:231], v[160:163]
    ds_read_b128 v[224:227], v12 offset:3072
    v_cvt_pk_bf16_f32 v86, v144, v145
    v_cvt_pk_bf16_f32 v87, v146, v147
    v_max_f32 v31, v128, v129
    v_mfma_f32_16x16x32_bf16 v[180:183], v[204:207], v[228:231], v[180:183]
    v_max3_f32 v31, v130, v131, v31
    v_max3_f32 v31, v148, v149, v31
    v_max3_f32 v31, v150, v151, v31
    s_waitcnt lgkmcnt(5)
    v_mfma_f32_16x16x32_bf16 v[164:167], v[196:199], v[232:235], v[164:167]
    ds_read_b128 v[228:231], v12 offset:4096
    v_cvt_pk_bf16_f32 v88, v128, v129
    v_cvt_pk_bf16_f32 v89, v130, v131
    v_cvt_pk_bf16_f32 v90, v148, v149
    v_mfma_f32_16x16x32_bf16 v[184:187], v[204:207], v[232:235], v[184:187]
    v_cvt_pk_bf16_f32 v91, v150, v151
    s_waitcnt lgkmcnt(5)
    v_mfma_f32_16x16x32_bf16 v[168:171], v[196:199], v[236:239], v[168:171]
    ds_read_b128 v[232:235], v12 offset:40960
    v_mfma_f32_16x16x32_bf16 v[188:191], v[204:207], v[236:239], v[188:191]
    s_waitcnt vmcnt(6)
    ds_read_b128 v[192:195], v5 offset:4096
    ds_read_b128 v[196:199], v6 offset:4096
    ds_read_b128 v[200:203], v5 offset:6144
    ds_read_b128 v[204:207], v6 offset:6144
    s_waitcnt lgkmcnt(9)
    v_mfma_f32_16x16x32_bf16 v[152:155], v[208:211], v[240:243], v[152:155]
    ds_read_b128 v[236:239], v12 offset:41984
    v_mfma_f32_16x16x32_bf16 v[172:175], v[216:219], v[240:243], v[172:175]
    s_waitcnt lgkmcnt(9)
    v_mfma_f32_16x16x32_bf16 v[156:159], v[208:211], v[244:247], v[156:159]
    ds_read_b128 v[240:243], v12 offset:43008
    v_mfma_f32_16x16x32_bf16 v[176:179], v[216:219], v[244:247], v[176:179]
    s_waitcnt lgkmcnt(9)
    v_mfma_f32_16x16x32_bf16 v[160:163], v[208:211], v[248:251], v[160:163]
    ds_read_b128 v[244:247], v12 offset:44032
    v_mfma_f32_16x16x32_bf16 v[180:183], v[216:219], v[248:251], v[180:183]
    s_waitcnt lgkmcnt(9)
    v_mfma_f32_16x16x32_bf16 v[164:167], v[208:211], v[224:227], v[164:167]
    ds_read_b128 v[248:251], v12 offset:45056
    v_mfma_f32_16x16x32_bf16 v[184:187], v[216:219], v[224:227], v[184:187]
    s_waitcnt lgkmcnt(4)
    s_add_u32 m0, s48, 4096
    s_xor_b32 s49, s28, 8192
    buffer_load_dwordx4 v3, s[36:39], s49 offen nt lds
    v_mfma_f32_16x16x32_bf16 v[168:171], v[208:211], v[228:231], v[168:171]
    ds_read_b128 v[224:227], v14 offset:0
    v_mfma_f32_16x16x32_bf16 v[188:191], v[216:219], v[228:231], v[188:191]
    s_add_u32 m0, s48, 5120
    s_xor_b32 s49, s28, 12288
    buffer_load_dwordx4 v3, s[36:39], s49 offen nt lds
    v_mfma_f32_16x16x32_bf16 v[152:155], v[212:215], v[232:235], v[152:155]
    ds_read_b128 v[228:231], v14 offset:1024
    v_mfma_f32_16x16x32_bf16 v[172:175], v[220:223], v[232:235], v[172:175]
    s_add_u32 m0, s48, 6144
    s_xor_b32 s49, s28, 65536
    buffer_load_dwordx4 v3, s[36:39], s49 offen nt lds
    s_waitcnt lgkmcnt(5)
    v_mfma_f32_16x16x32_bf16 v[156:159], v[212:215], v[236:239], v[156:159]
    ds_read_b128 v[232:235], v14 offset:2048
    v_mfma_f32_16x16x32_bf16 v[176:179], v[220:223], v[236:239], v[176:179]
    s_add_u32 m0, s48, 7168
    s_xor_b32 s49, s28, 69632
    buffer_load_dwordx4 v3, s[36:39], s49 offen nt lds
    s_waitcnt lgkmcnt(5)
    v_mfma_f32_16x16x32_bf16 v[160:163], v[212:215], v[240:243], v[160:163]
    ds_read_b128 v[236:239], v14 offset:3072
    v_mfma_f32_16x16x32_bf16 v[180:183], v[220:223], v[240:243], v[180:183]
    s_waitcnt lgkmcnt(5)
    v_mfma_f32_16x16x32_bf16 v[164:167], v[212:215], v[244:247], v[164:167]
    ds_read_b128 v[240:243], v14 offset:4096
    v_mfma_f32_16x16x32_bf16 v[184:187], v[220:223], v[244:247], v[184:187]
    s_waitcnt lgkmcnt(5)
    v_mfma_f32_16x16x32_bf16 v[168:171], v[212:215], v[248:251], v[168:171]
    ds_read_b128 v[244:247], v14 offset:40960
    v_mfma_f32_16x16x32_bf16 v[188:191], v[220:223], v[248:251], v[188:191]
    s_waitcnt vmcnt(6)
    ds_read_b128 v[208:211], v5 offset:8192
    ds_read_b128 v[212:215], v6 offset:8192
    ds_read_b128 v[216:219], v5 offset:0
    ds_read_b128 v[220:223], v6 offset:0
    s_waitcnt lgkmcnt(9)
    v_mfma_f32_16x16x32_bf16 v[152:155], v[192:195], v[224:227], v[152:155]
    ds_read_b128 v[248:251], v14 offset:41984
    v_mfma_f32_16x16x32_bf16 v[172:175], v[200:203], v[224:227], v[172:175]
    s_waitcnt lgkmcnt(9)
    v_mfma_f32_16x16x32_bf16 v[156:159], v[192:195], v[228:231], v[156:159]
    ds_read_b128 v[224:227], v14 offset:43008
    v_mfma_f32_16x16x32_bf16 v[176:179], v[200:203], v[228:231], v[176:179]
    s_waitcnt lgkmcnt(9)
    v_mfma_f32_16x16x32_bf16 v[160:163], v[192:195], v[232:235], v[160:163]
    ds_read_b128 v[228:231], v14 offset:44032
    v_mfma_f32_16x16x32_bf16 v[180:183], v[200:203], v[232:235], v[180:183]
    s_waitcnt lgkmcnt(9)
    v_mfma_f32_16x16x32_bf16 v[164:167], v[192:195], v[236:239], v[164:167]
    ds_read_b128 v[232:235], v14 offset:45056
    v_mfma_f32_16x16x32_bf16 v[184:187], v[200:203], v[236:239], v[184:187]
    s_waitcnt lgkmcnt(4)
    s_add_u32 m0, s48, 8192
    s_xor_b32 s49, s28, 73728
    buffer_load_dwordx4 v3, s[36:39], s49 offen nt lds
    v_mfma_f32_16x16x32_bf16 v[168:171], v[192:195], v[240:243], v[168:171]
    ds_read_b128 v[236:239], v15 offset:0
    v_mfma_f32_16x16x32_bf16 v[188:191], v[200:203], v[240:243], v[188:191]
    s_add_u32 m0, s48, 9216
    s_xor_b32 s49, s28, 77824
    buffer_load_dwordx4 v3, s[36:39], s49 offen nt lds
    v_mfma_f32_16x16x32_bf16 v[152:155], v[196:199], v[244:247], v[152:155]
    ds_read_b128 v[240:243], v15 offset:1024
    v_mfma_f32_16x16x32_bf16 v[172:175], v[204:207], v[244:247], v[172:175]
    s_add_u32 m0, s48, 0
    s_xor_b32 s49, s28, 131072
    buffer_load_dwordx4 v3, s[36:39], s49 offen nt lds
    s_waitcnt lgkmcnt(5)
    v_mfma_f32_16x16x32_bf16 v[156:159], v[196:199], v[248:251], v[156:159]
    ds_read_b128 v[244:247], v15 offset:2048
    v_mfma_f32_16x16x32_bf16 v[176:179], v[204:207], v[248:251], v[176:179]
    s_add_u32 m0, s48, 1024
    s_xor_b32 s49, s28, 135168
    buffer_load_dwordx4 v3, s[36:39], s49 offen nt lds
    s_waitcnt lgkmcnt(5)
    v_mfma_f32_16x16x32_bf16 v[160:163], v[196:199], v[224:227], v[160:163]
    ds_read_b128 v[248:251], v15 offset:3072
    v_mfma_f32_16x16x32_bf16 v[180:183], v[204:207], v[224:227], v[180:183]
    s_waitcnt lgkmcnt(5)
    v_mfma_f32_16x16x32_bf16 v[164:167], v[196:199], v[228:231], v[164:167]
    ds_read_b128 v[224:227], v15 offset:4096
    v_mfma_f32_16x16x32_bf16 v[184:187], v[204:207], v[228:231], v[184:187]
    s_waitcnt lgkmcnt(5)
    v_mfma_f32_16x16x32_bf16 v[168:171], v[196:199], v[232:235], v[168:171]
    ds_read_b128 v[228:231], v15 offset:40960
    v_mfma_f32_16x16x32_bf16 v[188:191], v[204:207], v[232:235], v[188:191]
    s_waitcnt lgkmcnt(5)
    v_mfma_f32_16x16x32_bf16 v[152:155], v[208:211], v[236:239], v[152:155]
    ds_read_b128 v[232:235], v15 offset:41984
    v_mfma_f32_16x16x32_bf16 v[172:175], v[216:219], v[236:239], v[172:175]
    s_waitcnt lgkmcnt(5)
    v_mfma_f32_16x16x32_bf16 v[156:159], v[208:211], v[240:243], v[156:159]
    ds_read_b128 v[236:239], v15 offset:43008
    v_mfma_f32_16x16x32_bf16 v[176:179], v[216:219], v[240:243], v[176:179]
    s_waitcnt lgkmcnt(5)
    v_mfma_f32_16x16x32_bf16 v[160:163], v[208:211], v[244:247], v[160:163]
    ds_read_b128 v[240:243], v15 offset:44032
    v_mfma_f32_16x16x32_bf16 v[180:183], v[216:219], v[244:247], v[180:183]
    s_waitcnt lgkmcnt(5)
    v_mfma_f32_16x16x32_bf16 v[164:167], v[208:211], v[248:251], v[164:167]
    ds_read_b128 v[244:247], v15 offset:45056
    v_mfma_f32_16x16x32_bf16 v[184:187], v[216:219], v[248:251], v[184:187]
    s_waitcnt lgkmcnt(5)
    v_mfma_f32_16x16x32_bf16 v[168:171], v[208:211], v[224:227], v[168:171]
    v_mfma_f32_16x16x32_bf16 v[188:191], v[216:219], v[224:227], v[188:191]
    s_waitcnt lgkmcnt(4)
    v_mfma_f32_16x16x32_bf16 v[152:155], v[212:215], v[228:231], v[152:155]
    v_mfma_f32_16x16x32_bf16 v[172:175], v[220:223], v[228:231], v[172:175]
    s_waitcnt lgkmcnt(3)
    v_mfma_f32_16x16x32_bf16 v[156:159], v[212:215], v[232:235], v[156:159]
    v_mfma_f32_16x16x32_bf16 v[176:179], v[220:223], v[232:235], v[176:179]
    s_waitcnt lgkmcnt(2)
    v_mfma_f32_16x16x32_bf16 v[160:163], v[212:215], v[236:239], v[160:163]
    v_mfma_f32_16x16x32_bf16 v[180:183], v[220:223], v[236:239], v[180:183]
    s_waitcnt lgkmcnt(1)
    v_mfma_f32_16x16x32_bf16 v[164:167], v[212:215], v[240:243], v[164:167]
    v_mfma_f32_16x16x32_bf16 v[184:187], v[220:223], v[240:243], v[184:187]
    s_waitcnt lgkmcnt(0)
    v_mfma_f32_16x16x32_bf16 v[168:171], v[212:215], v[244:247], v[168:171]
    v_mfma_f32_16x16x32_bf16 v[188:191], v[220:223], v[244:247], v[188:191]
    v_max3_f32 v252, v152, v153, v252
    v_max3_f32 v252, v154, v155, v252
    v_max3_f32 v252, v172, v173, v252
    v_max3_f32 v252, v174, v175, v252
    v_cvt_pk_bf16_f32 v92, v152, v153
    v_cvt_pk_bf16_f32 v93, v154, v155
    v_cvt_pk_bf16_f32 v94, v172, v173
    v_cvt_pk_bf16_f32 v95, v174, v175
    v_max3_f32 v253, v156, v157, v253
    v_max3_f32 v253, v158, v159, v253
    v_max3_f32 v253, v176, v177, v253
    v_max3_f32 v253, v178, v179, v253
    v_cvt_pk_bf16_f32 v96, v156, v157
    v_cvt_pk_bf16_f32 v97, v158, v159
    v_cvt_pk_bf16_f32 v98, v176, v177
    v_cvt_pk_bf16_f32 v99, v178, v179
    v_max3_f32 v254, v160, v161, v254
    v_max3_f32 v254, v162, v163, v254
    v_max3_f32 v254, v180, v181, v254
    v_max3_f32 v254, v182, v183, v254
    v_cvt_pk_bf16_f32 v100, v160, v161
    v_cvt_pk_bf16_f32 v101, v162, v163
    v_cvt_pk_bf16_f32 v102, v180, v181
    v_cvt_pk_bf16_f32 v103, v182, v183
    v_max3_f32 v255, v164, v165, v255
    v_max3_f32 v255, v166, v167, v255
    v_max3_f32 v255, v184, v185, v255
    v_max3_f32 v255, v186, v187, v255
    v_cvt_pk_bf16_f32 v104, v164, v165
    v_cvt_pk_bf16_f32 v105, v166, v167
    v_cvt_pk_bf16_f32 v106, v184, v185
    v_cvt_pk_bf16_f32 v107, v186, v187
    v_max3_f32 v31, v168, v169, v31
    v_max3_f32 v31, v170, v171, v31
    v_max3_f32 v31, v188, v189, v31
    v_max3_f32 v31, v190, v191, v31
    v_cvt_pk_bf16_f32 v108, v168, v169
    v_cvt_pk_bf16_f32 v109, v170, v171
    v_cvt_pk_bf16_f32 v110, v188, v189
    v_cvt_pk_bf16_f32 v111, v190, v191
    v_and_b32 v2, 15, v1
    v_lshlrev_b32 v2, 5, v2
    v_add_u32 v2, 122880, v2
    v_mul_f32 v240, s54, v252
    v_ceil_f32 v240, v240
    v_max_f32 v240, v240, v16
    ds_max_f32 v2, v240 offset:35840
    v_mul_f32 v241, s54, v253
    v_ceil_f32 v241, v241
    v_max_f32 v241, v241, v17
    ds_max_f32 v2, v241 offset:35844
    v_mul_f32 v242, s54, v254
    v_ceil_f32 v242, v242
    v_max_f32 v242, v242, v18
    ds_max_f32 v2, v242 offset:35848
    v_mul_f32 v243, s54, v255
    v_ceil_f32 v243, v243
    v_max_f32 v243, v243, v19
    ds_max_f32 v2, v243 offset:35852
    v_mul_f32 v244, s54, v31
    v_ceil_f32 v244, v244
    v_max_f32 v244, v244, v20
    ds_max_f32 v2, v244 offset:35856
    s_waitcnt vmcnt(6) lgkmcnt(0)
    s_cmp_lg_u32 s9, 0
    s_cbranch_scc1 L_noann
    s_lshr_b32 s50, s2, 4
    s_lshl_b32 s50, s50, 4
    v_mov_b32 v246, s50
    v_mov_b32 v247, 1
    s_mov_b64 exec, 1
    s_waitcnt vmcnt(0)
    global_atomic_add v246, v247, s[58:59]
    s_mov_b64 exec, -1
L_noann:
    s_xor_b32 s49, s9, 4
    s_mul_i32 s49, s49, 10240
    s_sub_u32 s49, s49, s48
    v_add_u32 v176, s49, v7
    v_add_u32 v177, s49, v8
    s_barrier
    ds_read_b128 v[112:115], v2 offset:35840
    ds_read_b32 v116, v2 offset:35856
    ds_read_b64_tr_b16 v[192:193], v7 offset:2048
    ds_read_b64_tr_b16 v[194:195], v7 offset:4096
    ds_read_b64_tr_b16 v[196:197], v8 offset:2048
    ds_read_b64_tr_b16 v[198:199], v8 offset:4096
    ds_read_b64_tr_b16 v[200:201], v176 offset:2048
    ds_read_b64_tr_b16 v[202:203], v176 offset:4096
    ds_read_b64_tr_b16 v[204:205], v177 offset:2048
    ds_read_b64_tr_b16 v[206:207], v177 offset:4096
    s_waitcnt lgkmcnt(8)
    v_sub_f32 v120, v16, v112
    v_max_f32 v120, 0xc37f0000, v120
    v_cvt_i32_f32 v120, v120
    v_ldexp_f32 v21, v21, v120
    v_sub_u32 v120, 0, v120
    v_add_u32_sdwa v125, v120, v26 dst_sel:DWORD dst_unused:UNUSED_PAD src0_sel:DWORD src1_sel:BYTE_0
    v_min_u32 v125, 0xff, v125
    v_mul_u32_u24 v125, 0x800080, v125
    v_sub_f32 v16, 0, v112
    v_sub_f32 v121, v17, v113
    v_max_f32 v121, 0xc37f0000, v121
    v_cvt_i32_f32 v121, v121
    v_ldexp_f32 v22, v22, v121
    v_sub_u32 v121, 0, v121
    v_add_u32_sdwa v126, v121, v27 dst_sel:DWORD dst_unused:UNUSED_PAD src0_sel:DWORD src1_sel:BYTE_0
    v_min_u32 v126, 0xff, v126
    v_mul_u32_u24 v126, 0x800080, v126
    v_sub_f32 v17, 0, v113
    v_sub_f32 v122, v18, v114
    v_max_f32 v122, 0xc37f0000, v122
    v_cvt_i32_f32 v122, v122
    v_ldexp_f32 v23, v23, v122
    v_sub_u32 v122, 0, v122
    v_add_u32_sdwa v127, v122, v28 dst_sel:DWORD dst_unused:UNUSED_PAD src0_sel:DWORD src1_sel:BYTE_0
    v_min_u32 v127, 0xff, v127
    v_mul_u32_u24 v127, 0x800080, v127
    v_sub_f32 v18, 0, v114
    v_sub_f32 v123, v19, v115
    v_max_f32 v123, 0xc37f0000, v123
    v_cvt_i32_f32 v123, v123
    v_ldexp_f32 v24, v24, v123
    v_sub_u32 v123, 0, v123
    v_add_u32_sdwa v128, v123, v29 dst_sel:DWORD dst_unused:UNUSED_PAD src0_sel:DWORD src1_sel:BYTE_0
    v_min_u32 v128, 0xff, v128
    v_mul_u32_u24 v128, 0x800080, v128
    v_sub_f32 v19, 0, v115
    v_sub_f32 v124, v20, v116
    v_max_f32 v124, 0xc37f0000, v124
    v_cvt_i32_f32 v124, v124
    v_ldexp_f32 v25, v25, v124
    v_sub_u32 v124, 0, v124
    v_add_u32_sdwa v129, v124, v30 dst_sel:DWORD dst_unused:UNUSED_PAD src0_sel:DWORD src1_sel:BYTE_0
    v_min_u32 v129, 0xff, v129
    v_mul_u32_u24 v129, 0x800080, v129
    v_sub_f32 v20, 0, v116
    v_pk_sub_u16 v32, v32, v125 clamp
    v_pk_sub_u16 v33, v33, v125 clamp
    v_pk_sub_u16 v34, v34, v125 clamp
    v_pk_sub_u16 v35, v35, v125 clamp
    ds_write_b128 v13, v[32:35] offset:0
    v_pk_sub_u16 v36, v36, v126 clamp
    v_pk_sub_u16 v37, v37, v126 clamp
    v_pk_sub_u16 v38, v38, v126 clamp
    v_pk_sub_u16 v39, v39, v126 clamp
    ds_write_b128 v13, v[36:39] offset:1024
    v_pk_sub_u16 v40, v40, v127 clamp
    v_pk_sub_u16 v41, v41, v127 clamp
    v_pk_sub_u16 v42, v42, v127 clamp
    v_pk_sub_u16 v43, v43, v127 clamp
    ds_write_b128 v13, v[40:43] offset:2048
    v_pk_sub_u16 v44, v44, v128 clamp
    v_pk_sub_u16 v45, v45, v128 clamp
    v_pk_sub_u16 v46, v46, v128 clamp
    v_pk_sub_u16 v47, v47, v128 clamp
    ds_write_b128 v13, v[44:47] offset:3072
    v_pk_sub_u16 v48, v48, v129 clamp
    v_pk_sub_u16 v49, v49, v129 clamp
    v_pk_sub_u16 v50, v50, v129 clamp
    v_pk_sub_u16 v51, v51, v129 clamp
    ds_write_b128 v13, v[48:51] offset:4096
    v_min_u32 v120, 0xff, v120
    v_mul_u32_u24 v26, 0x800080, v120
    v_min_u32 v121, 0xff, v121
    v_mul_u32_u24 v27, 0x800080, v121
    v_min_u32 v122, 0xff, v122
    v_mul_u32_u24 v28, 0x800080, v122
    v_min_u32 v123, 0xff, v123
    v_mul_u32_u24 v29, 0x800080, v123
    v_min_u32 v124, 0xff, v124
    v_mul_u32_u24 v30, 0x800080, v124
    s_mul_i32 s49, s11, 20480
    v_add_u32 v31, s49, v11
    s_xor_b32 s49, s49, 20480
    v_add_u32 v174, s49, v11
    s_waitcnt vmcnt(2) lgkmcnt(0)
    s_barrier
    ds_read_b128 v[224:227], v31 offset:0
    ds_read_b128 v[228:231], v31 offset:1024
    ds_read_b128 v[232:235], v31 offset:2048
    ds_read_b128 v[236:239], v31 offset:3072
    ds_read_b128 v[240:243], v31 offset:4096
    ds_read_b128 v[152:155], v174 offset:0
    ds_read_b128 v[156:159], v174 offset:1024
    ds_read_b128 v[160:163], v174 offset:2048
    ds_read_b64_tr_b16 v[208:209], v7 offset:6144
    ds_read_b64_tr_b16 v[210:211], v7 offset:8192
    ds_read_b64_tr_b16 v[212:213], v8 offset:6144
    ds_read_b64_tr_b16 v[214:215], v8 offset:8192
    ds_read_b64_tr_b16 v[216:217], v176 offset:6144
    ds_read_b64_tr_b16 v[218:219], v176 offset:8192
    ds_read_b64_tr_b16 v[220:221], v177 offset:6144
    ds_read_b64_tr_b16 v[222:223], v177 offset:8192
    s_waitcnt lgkmcnt(15)
    v_mfma_f32_16x16x32_bf16 v[112:115], v[192:195], v[224:227], 0
    ds_read_b128 v[164:167], v174 offset:3072
    v_pk_sub_u16 v52, v52, v26 clamp
    v_pk_sub_u16 v53, v53, v26 clamp
    v_pk_sub_u16 v54, v54, v26 clamp
    v_mfma_f32_16x16x32_bf16 v[132:135], v[196:199], v[224:227], 0
    v_pk_sub_u16 v55, v55, v26 clamp
    ds_write_b128 v13, v[52:55] offset:40960
    v_pk_sub_u16 v56, v56, v27 clamp
    s_add_u32 m0, s48, 2048
    s_xor_b32 s49, s28, 139264
    buffer_load_dwordx4 v3, s[36:39], s49 offen nt lds
    s_waitcnt lgkmcnt(15)
    v_mfma_f32_16x16x32_bf16 v[116:119], v[192:195], v[228:231], 0
    ds_read_b128 v[224:227], v174 offset:4096
    v_pk_sub_u16 v57, v57, v27 clamp
    v_pk_sub_u16 v58, v58, v27 clamp
    v_pk_sub_u16 v59, v59, v27 clamp
    v_mfma_f32_16x16x32_bf16 v[136:139], v[196:199], v[228:231], 0
    ds_write_b128 v13, v[56:59] offset:41984
    v_pk_sub_u16 v60, v60, v28 clamp
    v_pk_sub_u16 v61, v61, v28 clamp
    s_add_u32 m0, s48, 3072
    s_xor_b32 s49, s28, 143360
    buffer_load_dwordx4 v3, s[36:39], s49 offen nt lds
    v_mfma_f32_16x16x32_bf16 v[120:123], v[192:195], v[232:235], 0
    ds_read_b128 v[228:231], v31 offset:5120
    v_pk_sub_u16 v62, v62, v28 clamp
    v_pk_sub_u16 v63, v63, v28 clamp
    ds_write_b128 v13, v[60:63] offset:43008
    v_mfma_f32_16x16x32_bf16 v[140:143], v[196:199], v[232:235], 0
    v_pk_sub_u16 v64, v64, v29 clamp
    v_pk_sub_u16 v65, v65, v29 clamp
    v_pk_sub_u16 v66, v66, v29 clamp
    s_add_u32 m0, s48, 4096
    s_xor_b32 s49, s28, 196608
    buffer_load_dwordx4 v3, s[36:39], s49 offen nt lds
    s_waitcnt lgkmcnt(6)
    s_barrier
    s_add_u32 m0, s48, 5120
    s_xor_b32 s49, s28, 200704
    buffer_load_dwordx4 v3, s[36:39], s49 offen nt lds
    v_mfma_f32_16x16x32_bf16 v[124:127], v[192:195], v[236:239], 0
    ds_read_b128 v[232:235], v31 offset:6144
    v_pk_sub_u16 v67, v67, v29 clamp
    ds_write_b128 v13, v[64:67] offset:44032
    v_pk_sub_u16 v68, v68, v30 clamp
    v_mfma_f32_16x16x32_bf16 v[144:147], v[196:199], v[236:239], 0
    v_pk_sub_u16 v69, v69, v30 clamp
    v_pk_sub_u16 v70, v70, v30 clamp
    v_pk_sub_u16 v71, v71, v30 clamp
    s_add_u32 m0, s48, 6144
    s_xor_b32 s49, s28, 204800
    buffer_load_dwordx4 v3, s[36:39], s49 offen nt lds
    v_mfma_f32_16x16x32_bf16 v[128:131], v[192:195], v[240:243], 0
    ds_read_b128 v[236:239], v31 offset:7168
    ds_write_b128 v13, v[68:71] offset:45056
    v_lshlrev_b32 v244, 16, v72
    v_and_b32 v245, s53, v72
    v_mfma_f32_16x16x32_bf16 v[148:151], v[196:199], v[240:243], 0
    v_fma_f32 v244, v244, s54, v16
    v_fma_f32 v245, v245, s54, v16
    v_exp_f32 v244, v244
    s_add_u32 m0, s48, 7168
    s_xor_b32 s49, s28, 208896
    buffer_load_dwordx4 v3, s[36:39], s49 offen nt lds
    v_mfma_f32_16x16x32_bf16 v[112:115], v[200:203], v[152:155], v[112:115]
    ds_read_b128 v[240:243], v31 offset:8192
    v_exp_f32 v245, v245
    v_add_f32 v21, v21, v244
    v_add_f32 v21, v21, v245
    v_mfma_f32_16x16x32_bf16 v[132:135], v[204:207], v[152:155], v[132:135]
    v_cvt_pk_bf16_f32 v72, v244, v245
    v_lshlrev_b32 v246, 16, v73
    v_and_b32 v247, s53, v73
    s_add_u32 m0, s48, 8192
    s_xor_b32 s49, s28, 16384
    buffer_load_dwordx4 v3, s[36:39], s49 offen nt lds
    v_mfma_f32_16x16x32_bf16 v[116:119], v[200:203], v[156:159], v[116:119]
    ds_read_b128 v[152:155], v31 offset:9216
    v_fma_f32 v246, v246, s54, v16
    v_fma_f32 v247, v247, s54, v16
    v_exp_f32 v246, v246
    v_mfma_f32_16x16x32_bf16 v[136:139], v[204:207], v[156:159], v[136:139]
    v_exp_f32 v247, v247
    v_add_f32 v21, v21, v246
    v_add_f32 v21, v21, v247
    s_add_u32 m0, s48, 9216
    s_xor_b32 s49, s28, 20480
    buffer_load_dwordx4 v3, s[36:39], s49 offen nt lds
    v_mfma_f32_16x16x32_bf16 v[120:123], v[200:203], v[160:163], v[120:123]
    ds_read_b128 v[156:159], v174 offset:5120
    v_cvt_pk_bf16_f32 v73, v246, v247
    v_lshlrev_b32 v248, 16, v74
    v_and_b32 v249, s53, v74
    v_mfma_f32_16x16x32_bf16 v[140:143], v[204:207], v[160:163], v[140:143]
    v_fma_f32 v248, v248, s54, v16
    v_fma_f32 v249, v249, s54, v16
    v_exp_f32 v248, v248
    s_waitcnt lgkmcnt(12)
    v_mfma_f32_16x16x32_bf16 v[124:127], v[200:203], v[164:167], v[124:127]
    ds_read_b128 v[160:163], v174 offset:6144
    v_exp_f32 v249, v249
    v_add_f32 v21, v21, v248
    v_add_f32 v21, v21, v249
    v_mfma_f32_16x16x32_bf16 v[144:147], v[204:207], v[164:167], v[144:147]
    v_cvt_pk_bf16_f32 v74, v248, v249
    v_lshlrev_b32 v250, 16, v75
    v_and_b32 v251, s53, v75
    s_waitcnt lgkmcnt(11)
    v_mfma_f32_16x16x32_bf16 v[128:131], v[200:203], v[224:227], v[128:131]
    ds_read_b128 v[164:167], v174 offset:7168
    v_fma_f32 v250, v250, s54, v16
    v_fma_f32 v251, v251, s54, v16
    v_exp_f32 v250, v250
    v_mfma_f32_16x16x32_bf16 v[148:151], v[204:207], v[224:227], v[148:151]
    v_exp_f32 v251, v251
    v_add_f32 v21, v21, v250
    v_add_f32 v21, v21, v251
    s_waitcnt vmcnt(6) lgkmcnt(5)
    s_barrier
    ds_read_b64_tr_b16 v[192:193], v7 offset:0
    ds_read_b64_tr_b16 v[194:195], v7 offset:2048
    ds_read_b64_tr_b16 v[196:197], v8 offset:0
    ds_read_b64_tr_b16 v[198:199], v8 offset:2048
    ds_read_b64_tr_b16 v[200:201], v176 offset:0
    ds_read_b64_tr_b16 v[202:203], v176 offset:2048
    ds_read_b64_tr_b16 v[204:205], v177 offset:0
    ds_read_b64_tr_b16 v[206:207], v177 offset:2048
    v_mfma_f32_16x16x32_bf16 v[112:115], v[208:211], v[228:231], v[112:115]
    ds_read_b128 v[224:227], v174 offset:8192
    v_cvt_pk_bf16_f32 v75, v250, v251
    v_lshlrev_b32 v244, 16, v76
    v_and_b32 v245, s53, v76
    v_mfma_f32_16x16x32_bf16 v[132:135], v[212:215], v[228:231], v[132:135]
    v_fma_f32 v244, v244, s54, v17
    v_fma_f32 v245, v245, s54, v17
    v_exp_f32 v244, v244
    v_mfma_f32_16x16x32_bf16 v[116:119], v[208:211], v[232:235], v[116:119]
    ds_read_b128 v[228:231], v174 offset:9216
    v_exp_f32 v245, v245
    v_add_f32 v22, v22, v244
    v_add_f32 v22, v22, v245
    v_mfma_f32_16x16x32_bf16 v[136:139], v[212:215], v[232:235], v[136:139]
    v_cvt_pk_bf16_f32 v76, v244, v245
    v_lshlrev_b32 v246, 16, v77
    v_and_b32 v247, s53, v77
    v_mfma_f32_16x16x32_bf16 v[120:123], v[208:211], v[236:239], v[120:123]
    ds_read_b128 v[232:235], v31 offset:10240
    v_fma_f32 v246, v246, s54, v17
    v_fma_f32 v247, v247, s54, v17
    v_exp_f32 v246, v246
    v_mfma_f32_16x16x32_bf16 v[140:143], v[212:215], v[236:239], v[140:143]
    v_exp_f32 v247, v247
    v_add_f32 v22, v22, v246
    v_add_f32 v22, v22, v247
    s_waitcnt lgkmcnt(3)
    s_barrier
    s_add_u32 m0, s48, 0
    s_xor_b32 s49, s28, 24576
    buffer_load_dwordx4 v3, s[36:39], s49 offen nt lds
    v_mfma_f32_16x16x32_bf16 v[124:127], v[208:211], v[240:243], v[124:127]
    ds_read_b128 v[236:239], v31 offset:11264
    v_cvt_pk_bf16_f32 v77, v246, v247
    v_lshlrev_b32 v248, 16, v78
    v_and_b32 v249, s53, v78
    v_mfma_f32_16x16x32_bf16 v[144:147], v[212:215], v[240:243], v[144:147]
    v_fma_f32 v248, v248, s54, v17
    v_fma_f32 v249, v249, s54, v17
    v_exp_f32 v248, v248
    s_add_u32 m0, s48, 1024
    s_xor_b32 s49, s28, 28672
    buffer_load_dwordx4 v3, s[36:39], s49 offen nt lds
    v_mfma_f32_16x16x32_bf16 v[128:131], v[208:211], v[152:155], v[128:131]
    ds_read_b128 v[240:243], v31 offset:12288
    v_exp_f32 v249, v249
    v_add_f32 v22, v22, v248
    v_add_f32 v22, v22, v249
    v_mfma_f32_16x16x32_bf16 v[148:151], v[212:215], v[152:155], v[148:151]
    v_cvt_pk_bf16_f32 v78, v248, v249
    v_lshlrev_b32 v250, 16, v79
    v_and_b32 v251, s53, v79
    s_add_u32 m0, s48, 2048
    s_xor_b32 s49, s28, 81920
    buffer_load_dwordx4 v3, s[36:39], s49 offen nt lds
    v_mfma_f32_16x16x32_bf16 v[112:115], v[216:219], v[156:159], v[112:115]
    ds_read_b128 v[152:155], v31 offset:13312
    v_fma_f32 v250, v250, s54, v17
    v_fma_f32 v251, v251, s54, v17
    v_exp_f32 v250, v250
    v_mfma_f32_16x16x32_bf16 v[132:135], v[220:223], v[156:159], v[132:135]
    v_exp_f32 v251, v251
    v_add_f32 v22, v22, v250
    v_add_f32 v22, v22, v251
    s_add_u32 m0, s48, 3072
    s_xor_b32 s49, s28, 86016
    buffer_load_dwordx4 v3, s[36:39], s49 offen nt lds
    v_mfma_f32_16x16x32_bf16 v[116:119], v[216:219], v[160:163], v[116:119]
    ds_read_b128 v[156:159], v31 offset:14336
    v_cvt_pk_bf16_f32 v79, v250, v251
    v_lshlrev_b32 v244, 16, v80
    v_and_b32 v245, s53, v80
    v_mfma_f32_16x16x32_bf16 v[136:139], v[220:223], v[160:163], v[136:139]
    v_fma_f32 v244, v244, s54, v18
    v_fma_f32 v245, v245, s54, v18
    v_exp_f32 v244, v244
    v_mfma_f32_16x16x32_bf16 v[120:123], v[216:219], v[164:167], v[120:123]
    ds_read_b128 v[160:163], v174 offset:10240
    v_exp_f32 v245, v245
    v_add_f32 v23, v23, v244
    v_add_f32 v23, v23, v245
    v_mfma_f32_16x16x32_bf16 v[140:143], v[220:223], v[164:167], v[140:143]
    v_cvt_pk_bf16_f32 v80, v244, v245
    v_lshlrev_b32 v246, 16, v81
    v_and_b32 v247, s53, v81
    s_waitcnt lgkmcnt(7)
    v_mfma_f32_16x16x32_bf16 v[124:127], v[216:219], v[224:227], v[124:127]
    ds_read_b128 v[164:167], v174 offset:11264
    v_fma_f32 v246, v246, s54, v18
    v_fma_f32 v247, v247, s54, v18
    v_exp_f32 v246, v246
    v_mfma_f32_16x16x32_bf16 v[144:147], v[220:223], v[224:227], v[144:147]
    v_exp_f32 v247, v247
    v_add_f32 v23, v23, v246
    v_add_f32 v23, v23, v247
    s_waitcnt lgkmcnt(7)
    v_mfma_f32_16x16x32_bf16 v[128:131], v[216:219], v[228:231], v[128:131]
    ds_read_b128 v[224:227], v174 offset:12288
    v_cvt_pk_bf16_f32 v81, v246, v247
    v_lshlrev_b32 v248, 16, v82
    v_and_b32 v249, s53, v82
    v_mfma_f32_16x16x32_bf16 v[148:151], v[220:223], v[228:231], v[148:151]
    v_fma_f32 v248, v248, s54, v18
    v_fma_f32 v249, v249, s54, v18
    v_exp_f32 v248, v248
    s_waitcnt vmcnt(6)
    s_barrier
    ds_read_b64_tr_b16 v[208:209], v7 offset:4096
    ds_read_b64_tr_b16 v[210:211], v7 offset:6144
    ds_read_b64_tr_b16 v[212:213], v8 offset:4096
    ds_read_b64_tr_b16 v[214:215], v8 offset:6144
    ds_read_b64_tr_b16 v[216:217], v176 offset:4096
    ds_read_b64_tr_b16 v[218:219], v176 offset:6144
    ds_read_b64_tr_b16 v[220:221], v177 offset:4096
    ds_read_b64_tr_b16 v[222:223], v177 offset:6144
    s_waitcnt lgkmcnt(15)
    v_mfma_f32_16x16x32_bf16 v[112:115], v[192:195], v[232:235], v[112:115]
    ds_read_b128 v[228:231], v174 offset:13312
    v_exp_f32 v249, v249
    v_add_f32 v23, v23, v248
    v_add_f32 v23, v23, v249
    v_mfma_f32_16x16x32_bf16 v[132:135], v[196:199], v[232:235], v[132:135]
    v_cvt_pk_bf16_f32 v82, v248, v249
    v_lshlrev_b32 v250, 16, v83
    v_and_b32 v251, s53, v83
    s_waitcnt lgkmcnt(15)
    v_mfma_f32_16x16x32_bf16 v[116:119], v[192:195], v[236:239], v[116:119]
    ds_read_b128 v[232:235], v174 offset:14336
    v_fma_f32 v250, v250, s54, v18
    v_fma_f32 v251, v251, s54, v18
    v_exp_f32 v250, v250
    v_mfma_f32_16x16x32_bf16 v[136:139], v[196:199], v[236:239], v[136:139]
    v_exp_f32 v251, v251
    v_add_f32 v23, v23, v250
    v_add_f32 v23, v23, v251
    s_waitcnt lgkmcnt(15)
    v_mfma_f32_16x16x32_bf16 v[120:123], v[192:195], v[240:243], v[120:123]
    ds_read_b128 v[236:239], v31 offset:15360
    v_cvt_pk_bf16_f32 v83, v250, v251
    v_lshlrev_b32 v244, 16, v84
    v_and_b32 v245, s53, v84
    v_mfma_f32_16x16x32_bf16 v[140:143], v[196:199], v[240:243], v[140:143]
    v_fma_f32 v244, v244, s54, v19
    v_fma_f32 v245, v245, s54, v19
    v_exp_f32 v244, v244
    s_waitcnt lgkmcnt(3)
    s_barrier
    s_add_u32 m0, s48, 4096
    s_xor_b32 s49, s28, 90112
    buffer_load_dwordx4 v3, s[36:39], s49 offen nt lds
    v_mfma_f32_16x16x32_bf16 v[124:127], v[192:195], v[152:155], v[124:127]
    ds_read_b128 v[240:243], v31 offset:16384
    v_exp_f32 v245, v245
    v_add_f32 v24, v24, v244
    v_add_f32 v24, v24, v245
    v_mfma_f32_16x16x32_bf16 v[144:147], v[196:199], v[152:155], v[144:147]
    v_cvt_pk_bf16_f32 v84, v244, v245
    v_lshlrev_b32 v246, 16, v85
    v_and_b32 v247, s53, v85
    s_add_u32 m0, s48, 5120
    s_xor_b32 s49, s28, 94208
    buffer_load_dwordx4 v3, s[36:39], s49 offen nt lds
    v_mfma_f32_16x16x32_bf16 v[128:131], v[192:195], v[156:159], v[128:131]
    ds_read_b128 v[152:155], v31 offset:17408
    v_fma_f32 v246, v246, s54, v19
    v_fma_f32 v247, v247, s54, v19
    v_exp_f32 v246, v246
    v_mfma_f32_16x16x32_bf16 v[148:151], v[196:199], v[156:159], v[148:151]
    v_exp_f32 v247, v247
    v_add_f32 v24, v24, v246
    v_add_f32 v24, v24, v247
    s_add_u32 m0, s48, 6144
    s_xor_b32 s49, s28, 147456
    buffer_load_dwordx4 v3, s[36:39], s49 offen nt lds
    v_mfma_f32_16x16x32_bf16 v[112:115], v[200:203], v[160:163], v[112:115]
    ds_read_b128 v[156:159], v31 offset:18432
    v_cvt_pk_bf16_f32 v85, v246, v247
    v_lshlrev_b32 v248, 16, v86
    v_and_b32 v249, s53, v86
    v_mfma_f32_16x16x32_bf16 v[132:135], v[204:207], v[160:163], v[132:135]
    v_fma_f32 v248, v248, s54, v19
    v_fma_f32 v249, v249, s54, v19
    v_exp_f32 v248, v248
    s_add_u32 m0, s48, 7168
    s_xor_b32 s49, s28, 151552
    buffer_load_dwordx4 v3, s[36:39], s49 offen nt lds
    v_mfma_f32_16x16x32_bf16 v[116:119], v[200:203], v[164:167], v[116:119]
    ds_read_b128 v[160:163], v31 offset:19456
    v_exp_f32 v249, v249
    v_add_f32 v24, v24, v248
    v_add_f32 v24, v24, v249
    v_mfma_f32_16x16x32_bf16 v[136:139], v[204:207], v[164:167], v[136:139]
    v_cvt_pk_bf16_f32 v86, v248, v249
    v_lshlrev_b32 v250, 16, v87
    v_and_b32 v251, s53, v87
    v_mfma_f32_16x16x32_bf16 v[120:123], v[200:203], v[224:227], v[120:123]
    ds_read_b128 v[164:167], v174 offset:15360
    v_fma_f32 v250, v250, s54, v19
    v_fma_f32 v251, v251, s54, v19
    v_exp_f32 v250, v250
    v_mfma_f32_16x16x32_bf16 v[140:143], v[204:207], v[224:227], v[140:143]
    v_exp_f32 v251, v251
    v_add_f32 v24, v24, v250
    v_add_f32 v24, v24, v251
    s_waitcnt lgkmcnt(7)
    v_mfma_f32_16x16x32_bf16 v[124:127], v[200:203], v[228:231], v[124:127]
    ds_read_b128 v[224:227], v174 offset:16384
    v_cvt_pk_bf16_f32 v87, v250, v251
    v_lshlrev_b32 v244, 16, v88
    v_and_b32 v245, s53, v88
    v_mfma_f32_16x16x32_bf16 v[144:147], v[204:207], v[228:231], v[144:147]
    v_fma_f32 v244, v244, s54, v20
    v_fma_f32 v245, v245, s54, v20
    v_exp_f32 v244, v244
    s_waitcnt lgkmcnt(7)
    v_mfma_f32_16x16x32_bf16 v[128:131], v[200:203], v[232:235], v[128:131]
    ds_read_b128 v[228:231], v174 offset:17408
    v_exp_f32 v245, v245
    v_add_f32 v25, v25, v244
    v_add_f32 v25, v25, v245
    v_mfma_f32_16x16x32_bf16 v[148:151], v[204:207], v[232:235], v[148:151]
    v_cvt_pk_bf16_f32 v88, v244, v245
    v_lshlrev_b32 v246, 16, v89
    v_and_b32 v247, s53, v89
    s_waitcnt vmcnt(6)
    s_barrier
    ds_read_b64_tr_b16 v[192:193], v7 offset:8192
    ds_read_b64_tr_b16 v[194:195], v7 offset:0
    ds_read_b64_tr_b16 v[196:197], v8 offset:8192
    ds_read_b64_tr_b16 v[198:199], v8 offset:0
    ds_read_b64_tr_b16 v[200:201], v176 offset:8192
    ds_read_b64_tr_b16 v[202:203], v176 offset:0
    ds_read_b64_tr_b16 v[204:205], v177 offset:8192
    ds_read_b64_tr_b16 v[206:207], v177 offset:0
    s_waitcnt lgkmcnt(15)
    v_mfma_f32_16x16x32_bf16 v[112:115], v[208:211], v[236:239], v[112:115]
    ds_read_b128 v[232:235], v174 offset:18432
    v_fma_f32 v246, v246, s54, v20
    v_fma_f32 v247, v247, s54, v20
    v_exp_f32 v246, v246
    v_mfma_f32_16x16x32_bf16 v[132:135], v[212:215], v[236:239], v[132:135]
    v_exp_f32 v247, v247
    v_add_f32 v25, v25, v246
    v_add_f32 v25, v25, v247
    s_waitcnt lgkmcnt(15)
    v_mfma_f32_16x16x32_bf16 v[116:119], v[208:211], v[240:243], v[116:119]
    ds_read_b128 v[236:239], v174 offset:19456
    v_cvt_pk_bf16_f32 v89, v246, v247
    v_lshlrev_b32 v248, 16, v90
    v_and_b32 v249, s53, v90
    v_mfma_f32_16x16x32_bf16 v[136:139], v[212:215], v[240:243], v[136:139]
    v_fma_f32 v248, v248, s54, v20
    v_fma_f32 v249, v249, s54, v20
    v_exp_f32 v248, v248
    s_waitcnt lgkmcnt(15)
    v_mfma_f32_16x16x32_bf16 v[120:123], v[208:211], v[152:155], v[120:123]
    ds_read_b128 v[240:243], v31 offset:40960
    v_exp_f32 v249, v249
    v_add_f32 v25, v25, v248
    v_add_f32 v25, v25, v249
    v_mfma_f32_16x16x32_bf16 v[140:143], v[212:215], v[152:155], v[140:143]
    v_cvt_pk_bf16_f32 v90, v248, v249
    v_lshlrev_b32 v250, 16, v91
    v_and_b32 v251, s53, v91
    s_waitcnt lgkmcnt(3)
    s_barrier
    s_add_u32 m0, s48, 8192
    s_xor_b32 s49, s28, 155648
    buffer_load_dwordx4 v3, s[36:39], s49 offen nt lds
    v_mfma_f32_16x16x32_bf16 v[124:127], v[208:211], v[156:159], v[124:127]
    ds_read_b128 v[152:155], v31 offset:41984
    v_fma_f32 v250, v250, s54, v20
    v_fma_f32 v251, v251, s54, v20
    v_exp_f32 v250, v250
    v_mfma_f32_16x16x32_bf16 v[144:147], v[212:215], v[156:159], v[144:147]
    v_exp_f32 v251, v251
    v_add_f32 v25, v25, v250
    v_add_f32 v25, v25, v251
    s_add_u32 m0, s48, 9216
    s_xor_b32 s49, s28, 159744
    buffer_load_dwordx4 v3, s[36:39], s49 offen nt lds
    v_mfma_f32_16x16x32_bf16 v[128:131], v[208:211], v[160:163], v[128:131]
    ds_read_b128 v[156:159], v31 offset:43008
    v_cvt_pk_bf16_f32 v91, v250, v251
    v_mfma_f32_16x16x32_bf16 v[148:151], v[212:215], v[160:163], v[148:151]
    s_add_u32 m0, s48, 0
    s_xor_b32 s49, s28, 212992
    buffer_load_dwordx4 v3, s[36:39], s49 offen nt lds
    v_mfma_f32_16x16x32_bf16 v[112:115], v[216:219], v[164:167], v[112:115]
    ds_read_b128 v[160:163], v31 offset:44032
    v_mfma_f32_16x16x32_bf16 v[132:135], v[220:223], v[164:167], v[132:135]
    s_add_u32 m0, s48, 1024
    s_xor_b32 s49, s28, 217088
    buffer_load_dwordx4 v3, s[36:39], s49 offen nt lds
    v_mfma_f32_16x16x32_bf16 v[116:119], v[216:219], v[224:227], v[116:119]
    ds_read_b128 v[164:167], v31 offset:45056
    v_mfma_f32_16x16x32_bf16 v[136:139], v[220:223], v[224:227], v[136:139]
    v_mfma_f32_16x16x32_bf16 v[120:123], v[216:219], v[228:231], v[120:123]
    ds_read_b128 v[224:227], v174 offset:40960
    v_mfma_f32_16x16x32_bf16 v[140:143], v[220:223], v[228:231], v[140:143]
    s_waitcnt lgkmcnt(7)
    v_mfma_f32_16x16x32_bf16 v[124:127], v[216:219], v[232:235], v[124:127]
    ds_read_b128 v[228:231], v174 offset:41984
    v_mfma_f32_16x16x32_bf16 v[144:147], v[220:223], v[232:235], v[144:147]
    s_waitcnt lgkmcnt(7)
    v_mfma_f32_16x16x32_bf16 v[128:131], v[216:219], v[236:239], v[128:131]
    ds_read_b128 v[232:235], v174 offset:43008
    v_mfma_f32_16x16x32_bf16 v[148:151], v[220:223], v[236:239], v[148:151]
    s_waitcnt vmcnt(6)
    s_barrier
    ds_read_b64_tr_b16 v[208:209], v7 offset:2048
    ds_read_b64_tr_b16 v[210:211], v7 offset:4096
    ds_read_b64_tr_b16 v[212:213], v8 offset:2048
    ds_read_b64_tr_b16 v[214:215], v8 offset:4096
    ds_read_b64_tr_b16 v[216:217], v176 offset:2048
    ds_read_b64_tr_b16 v[218:219], v176 offset:4096
    ds_read_b64_tr_b16 v[220:221], v177 offset:2048
    ds_read_b64_tr_b16 v[222:223], v177 offset:4096
    s_waitcnt lgkmcnt(15)
    v_mfma_f32_16x16x32_bf16 v[112:115], v[192:195], v[240:243], v[112:115]
    ds_read_b128 v[236:239], v174 offset:44032
    v_lshlrev_b32 v244, 16, v92
    v_and_b32 v245, s53, v92
    v_fma_f32 v244, v244, s54, v16
    v_mfma_f32_16x16x32_bf16 v[132:135], v[196:199], v[240:243], v[132:135]
    v_fma_f32 v245, v245, s54, v16
    v_exp_f32 v244, v244
    v_exp_f32 v245, v245
    ds_write_b128 v13, v[72:75] offset:0
    s_waitcnt lgkmcnt(15)
    v_mfma_f32_16x16x32_bf16 v[116:119], v[192:195], v[152:155], v[116:119]
    ds_read_b128 v[240:243], v174 offset:45056
    v_add_f32 v21, v21, v244
    v_add_f32 v21, v21, v245
    v_cvt_pk_bf16_f32 v92, v244, v245
    v_mfma_f32_16x16x32_bf16 v[136:139], v[196:199], v[152:155], v[136:139]
    v_lshlrev_b32 v246, 16, v93
    v_and_b32 v247, s53, v93
    v_fma_f32 v246, v246, s54, v16
    ds_write_b128 v13, v[76:79] offset:1024
    v_mfma_f32_16x16x32_bf16 v[120:123], v[192:195], v[156:159], v[120:123]
    ds_read_b128 v[152:155], v31 offset:46080
    v_fma_f32 v247, v247, s54, v16
    v_exp_f32 v246, v246
    v_exp_f32 v247, v247
    v_mfma_f32_16x16x32_bf16 v[140:143], v[196:199], v[156:159], v[140:143]
    v_add_f32 v21, v21, v246
    v_add_f32 v21, v21, v247
    v_cvt_pk_bf16_f32 v93, v246, v247
    ds_write_b128 v13, v[80:83] offset:2048
    s_waitcnt lgkmcnt(6)
    s_barrier
    s_add_u32 m0, s48, 2048
    s_xor_b32 s49, s28, 221184
    buffer_load_dwordx4 v3, s[36:39], s49 offen nt lds
    v_mfma_f32_16x16x32_bf16 v[124:127], v[192:195], v[160:163], v[124:127]
    ds_read_b128 v[156:159], v31 offset:47104
    v_lshlrev_b32 v248, 16, v94
    v_and_b32 v249, s53, v94
    v_fma_f32 v248, v248, s54, v16
    v_mfma_f32_16x16x32_bf16 v[144:147], v[196:199], v[160:163], v[144:147]
    v_fma_f32 v249, v249, s54, v16
    v_exp_f32 v248, v248
    v_exp_f32 v249, v249
    s_add_u32 m0, s48, 3072
    s_xor_b32 s49, s28, 225280
    buffer_load_dwordx4 v3, s[36:39], s49 offen nt lds
    ds_write_b128 v13, v[84:87] offset:3072
    v_mfma_f32_16x16x32_bf16 v[128:131], v[192:195], v[164:167], v[128:131]
    ds_read_b128 v[160:163], v31 offset:48128
    v_add_f32 v21, v21, v248
    v_add_f32 v21, v21, v249
    v_cvt_pk_bf16_f32 v94, v248, v249
    v_mfma_f32_16x16x32_bf16 v[148:151], v[196:199], v[164:167], v[148:151]
    v_lshlrev_b32 v250, 16, v95
    v_and_b32 v251, s53, v95
    v_fma_f32 v250, v250, s54, v16
    s_add_u32 m0, s48, 4096
    s_xor_b32 s49, s28, 32768
    buffer_load_dwordx4 v3, s[36:39], s49 offen nt lds
    ds_write_b128 v13, v[88:91] offset:4096
    v_mfma_f32_16x16x32_bf16 v[112:115], v[200:203], v[224:227], v[112:115]
    ds_read_b128 v[164:167], v31 offset:49152
    v_fma_f32 v251, v251, s54, v16
    v_exp_f32 v250, v250
    v_exp_f32 v251, v251
    v_mfma_f32_16x16x32_bf16 v[132:135], v[204:207], v[224:227], v[132:135]
    v_add_f32 v21, v21, v250
    v_add_f32 v21, v21, v251
    v_cvt_pk_bf16_f32 v95, v250, v251
    s_add_u32 m0, s48, 5120
    s_xor_b32 s49, s28, 36864
    buffer_load_dwordx4 v3, s[36:39], s49 offen nt lds
    v_mfma_f32_16x16x32_bf16 v[116:119], v[200:203], v[228:231], v[116:119]
    ds_read_b128 v[224:227], v31 offset:50176
    v_lshlrev_b32 v244, 16, v96
    v_and_b32 v245, s53, v96
    v_fma_f32 v244, v244, s54, v17
    v_mfma_f32_16x16x32_bf16 v[136:139], v[204:207], v[228:231], v[136:139]
    v_fma_f32 v245, v245, s54, v17
    v_exp_f32 v244, v244
    v_exp_f32 v245, v245
    v_mfma_f32_16x16x32_bf16 v[120:123], v[200:203], v[232:235], v[120:123]
    ds_read_b128 v[228:231], v174 offset:46080
    v_add_f32 v22, v22, v244
    v_add_f32 v22, v22, v245
    v_cvt_pk_bf16_f32 v96, v244, v245
    v_mfma_f32_16x16x32_bf16 v[140:143], v[204:207], v[232:235], v[140:143]
    v_lshlrev_b32 v246, 16, v97
    v_and_b32 v247, s53, v97
    v_fma_f32 v246, v246, s54, v17
    s_waitcnt lgkmcnt(12)
    v_mfma_f32_16x16x32_bf16 v[124:127], v[200:203], v[236:239], v[124:127]
    ds_read_b128 v[232:235], v174 offset:47104
    v_fma_f32 v247, v247, s54, v17
    v_exp_f32 v246, v246
    v_exp_f32 v247, v247
    v_mfma_f32_16x16x32_bf16 v[144:147], v[204:207], v[236:239], v[144:147]
    v_add_f32 v22, v22, v246
    v_add_f32 v22, v22, v247
    v_cvt_pk_bf16_f32 v97, v246, v247
    s_waitcnt lgkmcnt(11)
    v_mfma_f32_16x16x32_bf16 v[128:131], v[200:203], v[240:243], v[128:131]
    ds_read_b128 v[236:239], v174 offset:48128
    v_lshlrev_b32 v248, 16, v98
    v_and_b32 v249, s53, v98
    v_fma_f32 v248, v248, s54, v17
    v_mfma_f32_16x16x32_bf16 v[148:151], v[204:207], v[240:243], v[148:151]
    v_fma_f32 v249, v249, s54, v17
    v_exp_f32 v248, v248
    v_exp_f32 v249, v249
    s_waitcnt vmcnt(6) lgkmcnt(5)
    s_barrier
    ds_read_b64_tr_b16 v[192:193], v7 offset:6144
    ds_read_b64_tr_b16 v[194:195], v7 offset:8192
    ds_read_b64_tr_b16 v[196:197], v8 offset:6144
    ds_read_b64_tr_b16 v[198:199], v8 offset:8192
    ds_read_b64_tr_b16 v[200:201], v176 offset:6144
    ds_read_b64_tr_b16 v[202:203], v176 offset:8192
    ds_read_b64_tr_b16 v[204:205], v177 offset:6144
    ds_read_b64_tr_b16 v[206:207], v177 offset:8192
    v_mfma_f32_16x16x32_bf16 v[112:115], v[208:211], v[152:155], v[112:115]
    ds_read_b128 v[240:243], v174 offset:49152
    v_add_f32 v22, v22, v248
    v_add_f32 v22, v22, v249
    v_cvt_pk_bf16_f32 v98, v248, v249
    v_mfma_f32_16x16x32_bf16 v[132:135], v[212:215], v[152:155], v[132:135]
    v_lshlrev_b32 v250, 16, v99
    v_and_b32 v251, s53, v99
    v_fma_f32 v250, v250, s54, v17
    v_mfma_f32_16x16x32_bf16 v[116:119], v[208:211], v[156:159], v[116:119]
    ds_read_b128 v[152:155], v174 offset:50176
    v_fma_f32 v251, v251, s54, v17
    v_exp_f32 v250, v250
    v_exp_f32 v251, v251
    v_mfma_f32_16x16x32_bf16 v[136:139], v[212:215], v[156:159], v[136:139]
    v_add_f32 v22, v22, v250
    v_add_f32 v22, v22, v251
    v_cvt_pk_bf16_f32 v99, v250, v251
    v_mfma_f32_16x16x32_bf16 v[120:123], v[208:211], v[160:163], v[120:123]
    ds_read_b128 v[156:159], v31 offset:51200
    v_lshlrev_b32 v244, 16, v100
    v_and_b32 v245, s53, v100
    v_fma_f32 v244, v244, s54, v18
    v_mfma_f32_16x16x32_bf16 v[140:143], v[212:215], v[160:163], v[140:143]
    v_fma_f32 v245, v245, s54, v18
    v_exp_f32 v244, v244
    v_exp_f32 v245, v245
    s_waitcnt lgkmcnt(3)
    s_barrier
    s_add_u32 m0, s48, 6144
    s_xor_b32 s49, s28, 40960
    buffer_load_dwordx4 v3, s[36:39], s49 offen nt lds
    v_mfma_f32_16x16x32_bf16 v[124:127], v[208:211], v[164:167], v[124:127]
    ds_read_b128 v[160:163], v31 offset:52224
    v_add_f32 v23, v23, v244
    v_add_f32 v23, v23, v245
    v_cvt_pk_bf16_f32 v100, v244, v245
    v_mfma_f32_16x16x32_bf16 v[144:147], v[212:215], v[164:167], v[144:147]
    v_lshlrev_b32 v246, 16, v101
    v_and_b32 v247, s53, v101
    v_fma_f32 v246, v246, s54, v18
    s_add_u32 m0, s48, 7168
    s_xor_b32 s49, s28, 45056
    buffer_load_dwordx4 v3, s[36:39], s49 offen nt lds
    v_mfma_f32_16x16x32_bf16 v[128:131], v[208:211], v[224:227], v[128:131]
    ds_read_b128 v[164:167], v31 offset:53248
    v_fma_f32 v247, v247, s54, v18
    v_exp_f32 v246, v246
    v_exp_f32 v247, v247
    v_mfma_f32_16x16x32_bf16 v[148:151], v[212:215], v[224:227], v[148:151]
    v_add_f32 v23, v23, v246
    v_add_f32 v23, v23, v247
    v_cvt_pk_bf16_f32 v101, v246, v247
    s_add_u32 m0, s48, 8192
    s_xor_b32 s49, s28, 98304
    buffer_load_dwordx4 v3, s[36:39], s49 offen nt lds
    v_mfma_f32_16x16x32_bf16 v[112:115], v[216:219], v[228:231], v[112:115]
    ds_read_b128 v[224:227], v31 offset:54272
    v_lshlrev_b32 v248, 16, v102
    v_and_b32 v249, s53, v102
    v_fma_f32 v248, v248, s54, v18
    v_mfma_f32_16x16x32_bf16 v[132:135], v[220:223], v[228:231], v[132:135]
    v_fma_f32 v249, v249, s54, v18
    v_exp_f32 v248, v248
    v_exp_f32 v249, v249
    s_add_u32 m0, s48, 9216
    s_xor_b32 s49, s28, 102400
    buffer_load_dwordx4 v3, s[36:39], s49 offen nt lds
    v_mfma_f32_16x16x32_bf16 v[116:119], v[216:219], v[232:235], v[116:119]
    ds_read_b128 v[228:231], v31 offset:55296
    v_add_f32 v23, v23, v248
    v_add_f32 v23, v23, v249
    v_cvt_pk_bf16_f32 v102, v248, v249
    v_mfma_f32_16x16x32_bf16 v[136:139], v[220:223], v[232:235], v[136:139]
    v_lshlrev_b32 v250, 16, v103
    v_and_b32 v251, s53, v103
    v_fma_f32 v250, v250, s54, v18
    v_mfma_f32_16x16x32_bf16 v[120:123], v[216:219], v[236:239], v[120:123]
    ds_read_b128 v[232:235], v174 offset:51200
    v_fma_f32 v251, v251, s54, v18
    v_exp_f32 v250, v250
    v_exp_f32 v251, v251
    v_mfma_f32_16x16x32_bf16 v[140:143], v[220:223], v[236:239], v[140:143]
    v_add_f32 v23, v23, v250
    v_add_f32 v23, v23, v251
    v_cvt_pk_bf16_f32 v103, v250, v251
    s_waitcnt lgkmcnt(7)
    v_mfma_f32_16x16x32_bf16 v[124:127], v[216:219], v[240:243], v[124:127]
    ds_read_b128 v[236:239], v174 offset:52224
    v_lshlrev_b32 v244, 16, v104
    v_and_b32 v245, s53, v104
    v_fma_f32 v244, v244, s54, v19
    v_mfma_f32_16x16x32_bf16 v[144:147], v[220:223], v[240:243], v[144:147]
    v_fma_f32 v245, v245, s54, v19
    v_exp_f32 v244, v244
    v_exp_f32 v245, v245
    s_waitcnt lgkmcnt(7)
    v_mfma_f32_16x16x32_bf16 v[128:131], v[216:219], v[152:155], v[128:131]
    ds_read_b128 v[240:243], v174 offset:53248
    v_add_f32 v24, v24, v244
    v_add_f32 v24, v24, v245
    v_cvt_pk_bf16_f32 v104, v244, v245
    v_mfma_f32_16x16x32_bf16 v[148:151], v[220:223], v[152:155], v[148:151]
    v_lshlrev_b32 v246, 16, v105
    v_and_b32 v247, s53, v105
    v_fma_f32 v246, v246, s54, v19
    s_waitcnt vmcnt(6)
    s_barrier
    ds_read_b64_tr_b16 v[208:209], v7 offset:0
    ds_read_b64_tr_b16 v[210:211], v7 offset:2048
    ds_read_b64_tr_b16 v[212:213], v8 offset:0
    ds_read_b64_tr_b16 v[214:215], v8 offset:2048
    ds_read_b64_tr_b16 v[216:217], v176 offset:0
    ds_read_b64_tr_b16 v[218:219], v176 offset:2048
    ds_read_b64_tr_b16 v[220:221], v177 offset:0
    ds_read_b64_tr_b16 v[222:223], v177 offset:2048
    s_waitcnt lgkmcnt(15)
    v_mfma_f32_16x16x32_bf16 v[112:115], v[192:195], v[156:159], v[112:115]
    ds_read_b128 v[152:155], v174 offset:54272
    v_fma_f32 v247, v247, s54, v19
    v_exp_f32 v246, v246
    v_exp_f32 v247, v247
    v_mfma_f32_16x16x32_bf16 v[132:135], v[196:199], v[156:159], v[132:135]
    v_add_f32 v24, v24, v246
    v_add_f32 v24, v24, v247
    v_cvt_pk_bf16_f32 v105, v246, v247
    s_waitcnt lgkmcnt(15)
    v_mfma_f32_16x16x32_bf16 v[116:119], v[192:195], v[160:163], v[116:119]
    ds_read_b128 v[156:159], v174 offset:55296
    v_lshlrev_b32 v248, 16, v106
    v_and_b32 v249, s53, v106
    v_fma_f32 v248, v248, s54, v19
    v_mfma_f32_16x16x32_bf16 v[136:139], v[196:199], v[160:163], v[136:139]
    v_fma_f32 v249, v249, s54, v19
    v_exp_f32 v248, v248
    v_exp_f32 v249, v249
    s_waitcnt lgkmcnt(15)
    v_mfma_f32_16x16x32_bf16 v[120:123], v[192:195], v[164:167], v[120:123]
    ds_read_b128 v[160:163], v31 offset:56320
    v_add_f32 v24, v24, v248
    v_add_f32 v24, v24, v249
    v_cvt_pk_bf16_f32 v106, v248, v249
    v_mfma_f32_16x16x32_bf16 v[140:143], v[196:199], v[164:167], v[140:143]
    v_lshlrev_b32 v250, 16, v107
    v_and_b32 v251, s53, v107
    v_fma_f32 v250, v250, s54, v19
    s_waitcnt lgkmcnt(3)
    s_barrier
    s_add_u32 m0, s48, 0
    s_xor_b32 s49, s28, 106496
    buffer_load_dwordx4 v3, s[36:39], s49 offen nt lds
    v_mfma_f32_16x16x32_bf16 v[124:127], v[192:195], v[224:227], v[124:127]
    ds_read_b128 v[164:167], v31 offset:57344
    v_fma_f32 v251, v251, s54, v19
    v_exp_f32 v250, v250
    v_exp_f32 v251, v251
    v_mfma_f32_16x16x32_bf16 v[144:147], v[196:199], v[224:227], v[144:147]
    v_add_f32 v24, v24, v250
    v_add_f32 v24, v24, v251
    v_cvt_pk_bf16_f32 v107, v250, v251
    s_add_u32 m0, s48, 1024
    s_xor_b32 s49, s28, 110592
    buffer_load_dwordx4 v3, s[36:39], s49 offen nt lds
    v_mfma_f32_16x16x32_bf16 v[128:131], v[192:195], v[228:231], v[128:131]
    ds_read_b128 v[224:227], v31 offset:58368
    v_lshlrev_b32 v244, 16, v108
    v_and_b32 v245, s53, v108
    v_fma_f32 v244, v244, s54, v20
    v_mfma_f32_16x16x32_bf16 v[148:151], v[196:199], v[228:231], v[148:151]
    v_fma_f32 v245, v245, s54, v20
    v_exp_f32 v244, v244
    v_exp_f32 v245, v245
    s_add_u32 m0, s48, 2048
    s_xor_b32 s49, s28, 163840
    buffer_load_dwordx4 v3, s[36:39], s49 offen nt lds
    v_mfma_f32_16x16x32_bf16 v[112:115], v[200:203], v[232:235], v[112:115]
    ds_read_b128 v[228:231], v31 offset:59392
    v_add_f32 v25, v25, v244
    v_add_f32 v25, v25, v245
    v_cvt_pk_bf16_f32 v108, v244, v245
    v_mfma_f32_16x16x32_bf16 v[132:135], v[204:207], v[232:235], v[132:135]
    v_lshlrev_b32 v246, 16, v109
    v_and_b32 v247, s53, v109
    v_fma_f32 v246, v246, s54, v20
    s_add_u32 m0, s48, 3072
    s_xor_b32 s49, s28, 167936
    buffer_load_dwordx4 v3, s[36:39], s49 offen nt lds
    v_mfma_f32_16x16x32_bf16 v[116:119], v[200:203], v[236:239], v[116:119]
    ds_read_b128 v[232:235], v31 offset:60416
    v_fma_f32 v247, v247, s54, v20
    v_exp_f32 v246, v246
    v_exp_f32 v247, v247
    v_mfma_f32_16x16x32_bf16 v[136:139], v[204:207], v[236:239], v[136:139]
    v_add_f32 v25, v25, v246
    v_add_f32 v25, v25, v247
    v_cvt_pk_bf16_f32 v109, v246, v247
    v_mfma_f32_16x16x32_bf16 v[120:123], v[200:203], v[240:243], v[120:123]
    ds_read_b128 v[236:239], v174 offset:56320
    v_lshlrev_b32 v248, 16, v110
    v_and_b32 v249, s53, v110
    v_fma_f32 v248, v248, s54, v20
    v_mfma_f32_16x16x32_bf16 v[140:143], v[204:207], v[240:243], v[140:143]
    v_fma_f32 v249, v249, s54, v20
    v_exp_f32 v248, v248
    v_exp_f32 v249, v249
    s_waitcnt lgkmcnt(7)
    v_mfma_f32_16x16x32_bf16 v[124:127], v[200:203], v[152:155], v[124:127]
    ds_read_b128 v[240:243], v174 offset:57344
    v_add_f32 v25, v25, v248
    v_add_f32 v25, v25, v249
    v_cvt_pk_bf16_f32 v110, v248, v249
    v_mfma_f32_16x16x32_bf16 v[144:147], v[204:207], v[152:155], v[144:147]
    v_lshlrev_b32 v250, 16, v111
    v_and_b32 v251, s53, v111
    v_fma_f32 v250, v250, s54, v20
    s_waitcnt lgkmcnt(7)
    v_mfma_f32_16x16x32_bf16 v[128:131], v[200:203], v[156:159], v[128:131]
    ds_read_b128 v[152:155], v174 offset:58368
    v_fma_f32 v251, v251, s54, v20
    v_exp_f32 v250, v250
    v_exp_f32 v251, v251
    v_mfma_f32_16x16x32_bf16 v[148:151], v[204:207], v[156:159], v[148:151]
    v_add_f32 v25, v25, v250
    v_add_f32 v25, v25, v251
    v_cvt_pk_bf16_f32 v111, v250, v251
    s_waitcnt vmcnt(6)
    s_barrier
    ds_read_b64_tr_b16 v[192:193], v7 offset:4096
    ds_read_b64_tr_b16 v[194:195], v7 offset:6144
    ds_read_b64_tr_b16 v[196:197], v8 offset:4096
    ds_read_b64_tr_b16 v[198:199], v8 offset:6144
    ds_read_b64_tr_b16 v[200:201], v176 offset:4096
    ds_read_b64_tr_b16 v[202:203], v176 offset:6144
    ds_read_b64_tr_b16 v[204:205], v177 offset:4096
    ds_read_b64_tr_b16 v[206:207], v177 offset:6144
    s_waitcnt lgkmcnt(15)
    v_mfma_f32_16x16x32_bf16 v[112:115], v[208:211], v[160:163], v[112:115]
    ds_read_b128 v[156:159], v174 offset:59392
    v_mfma_f32_16x16x32_bf16 v[132:135], v[212:215], v[160:163], v[132:135]
    s_waitcnt lgkmcnt(15)
    v_mfma_f32_16x16x32_bf16 v[116:119], v[208:211], v[164:167], v[116:119]
    ds_read_b128 v[160:163], v174 offset:60416
    v_mfma_f32_16x16x32_bf16 v[136:139], v[212:215], v[164:167], v[136:139]
    s_waitcnt lgkmcnt(15)
    v_mfma_f32_16x16x32_bf16 v[120:123], v[208:211], v[224:227], v[120:123]
    ds_read_b128 v[164:167], v31 offset:0
    v_mfma_f32_16x16x32_bf16 v[140:143], v[212:215], v[224:227], v[140:143]
    s_waitcnt lgkmcnt(3)
    s_barrier
    s_add_u32 m0, s48, 4096
    s_xor_b32 s49, s28, 172032
    buffer_load_dwordx4 v3, s[36:39], s49 offen nt lds
    v_mfma_f32_16x16x32_bf16 v[124:127], v[208:211], v[228:231], v[124:127]
    ds_read_b128 v[224:227], v31 offset:1024
    v_mfma_f32_16x16x32_bf16 v[144:147], v[212:215], v[228:231], v[144:147]
    s_add_u32 m0, s48, 5120
    s_xor_b32 s49, s28, 176128
    buffer_load_dwordx4 v3, s[36:39], s49 offen nt lds
    v_mfma_f32_16x16x32_bf16 v[128:131], v[208:211], v[232:235], v[128:131]
    ds_read_b128 v[228:231], v31 offset:2048
    v_mfma_f32_16x16x32_bf16 v[148:151], v[212:215], v[232:235], v[148:151]
    s_add_u32 m0, s48, 6144
    s_add_u32 s49, s12, 0
    buffer_load_dwordx4 v4, s[40:43], s49 offen lds
    v_mfma_f32_16x16x32_bf16 v[112:115], v[216:219], v[236:239], v[112:115]
    ds_read_b128 v[232:235], v31 offset:3072
    v_mfma_f32_16x16x32_bf16 v[132:135], v[220:223], v[236:239], v[132:135]
    s_add_u32 m0, s48, 7168
    s_add_u32 s49, s12, 7168
    buffer_load_dwordx4 v4, s[40:43], s49 offen lds
    v_mfma_f32_16x16x32_bf16 v[116:119], v[216:219], v[240:243], v[116:119]
    ds_read_b128 v[236:239], v31 offset:4096
    v_mfma_f32_16x16x32_bf16 v[136:139], v[220:223], v[240:243], v[136:139]
    v_mfma_f32_16x16x32_bf16 v[120:123], v[216:219], v[152:155], v[120:123]
    ds_read_b128 v[240:243], v174 offset:0
    v_mfma_f32_16x16x32_bf16 v[140:143], v[220:223], v[152:155], v[140:143]
    s_waitcnt lgkmcnt(7)
    v_mfma_f32_16x16x32_bf16 v[124:127], v[216:219], v[156:159], v[124:127]
    ds_read_b128 v[152:155], v174 offset:1024
    v_mfma_f32_16x16x32_bf16 v[144:147], v[220:223], v[156:159], v[144:147]
    s_waitcnt lgkmcnt(7)
    v_mfma_f32_16x16x32_bf16 v[128:131], v[216:219], v[160:163], v[128:131]
    ds_read_b128 v[156:159], v174 offset:2048
    v_mfma_f32_16x16x32_bf16 v[148:151], v[220:223], v[160:163], v[148:151]
    s_waitcnt vmcnt(6)
    s_barrier
    ds_read_b64_tr_b16 v[208:209], v7 offset:8192
    ds_read_b64_tr_b16 v[210:211], v7 offset:0
    ds_read_b64_tr_b16 v[212:213], v8 offset:8192
    ds_read_b64_tr_b16 v[214:215], v8 offset:0
    ds_read_b64_tr_b16 v[216:217], v176 offset:8192
    ds_read_b64_tr_b16 v[218:219], v176 offset:0
    ds_read_b64_tr_b16 v[220:221], v177 offset:8192
    ds_read_b64_tr_b16 v[222:223], v177 offset:0
    s_waitcnt lgkmcnt(15)
    v_mfma_f32_16x16x32_bf16 v[112:115], v[192:195], v[164:167], v[112:115]
    ds_read_b128 v[160:163], v174 offset:3072
    v_mov_b32 v168, v21
    v_mov_b32 v169, v22
    v_mov_b32 v170, v23
    v_mfma_f32_16x16x32_bf16 v[132:135], v[196:199], v[164:167], v[132:135]
    v_mov_b32 v171, v24
    v_mov_b32 v172, v25
    v_permlane32_swap_b32 v21, v168
    ds_write_b128 v13, v[92:95] offset:40960
    s_waitcnt lgkmcnt(15)
    v_mfma_f32_16x16x32_bf16 v[116:119], v[192:195], v[224:227], v[116:119]
    ds_read_b128 v[164:167], v174 offset:4096
    v_permlane32_swap_b32 v22, v169
    v_permlane32_swap_b32 v23, v170
    v_permlane32_swap_b32 v24, v171
    v_mfma_f32_16x16x32_bf16 v[136:139], v[196:199], v[224:227], v[136:139]
    v_permlane32_swap_b32 v25, v172
    v_add_f32 v21, v21, v168
    v_mov_b32 v168, v21
    ds_write_b128 v13, v[96:99] offset:41984
    v_mfma_f32_16x16x32_bf16 v[120:123], v[192:195], v[228:231], v[120:123]
    ds_read_b128 v[224:227], v31 offset:5120
    v_add_f32 v22, v22, v169
    v_mov_b32 v169, v22
    v_add_f32 v23, v23, v170
    v_mfma_f32_16x16x32_bf16 v[140:143], v[196:199], v[228:231], v[140:143]
    v_mov_b32 v170, v23
    v_add_f32 v24, v24, v171
    v_mov_b32 v171, v24
    ds_write_b128 v13, v[100:103] offset:43008
    s_waitcnt lgkmcnt(6)
    s_barrier
    s_add_u32 m0, s48, 8192
    s_add_u32 s49, s12, 14336
    buffer_load_dwordx4 v4, s[40:43], s49 offen lds
    v_mfma_f32_16x16x32_bf16 v[124:127], v[192:195], v[232:235], v[124:127]
    ds_read_b128 v[228:231], v31 offset:6144
    v_add_f32 v25, v25, v172
    v_mov_b32 v172, v25
    v_permlane16_swap_b32 v21, v168
    v_mfma_f32_16x16x32_bf16 v[144:147], v[196:199], v[232:235], v[144:147]
    v_permlane16_swap_b32 v22, v169
    v_permlane16_swap_b32 v23, v170
    v_permlane16_swap_b32 v24, v171
    s_add_u32 m0, s48, 9216
    s_add_u32 s49, s12, 21504
    buffer_load_dwordx4 v4, s[40:43], s49 offen lds
    ds_write_b128 v13, v[104:107] offset:44032
    v_mfma_f32_16x16x32_bf16 v[128:131], v[192:195], v[236:239], v[128:131]
    ds_read_b128 v[232:235], v31 offset:7168
    v_permlane16_swap_b32 v25, v172
    v_add_f32 v21, v21, v168
    v_add_f32 v22, v22, v169
    v_mfma_f32_16x16x32_bf16 v[148:151], v[196:199], v[236:239], v[148:151]
    v_add_f32 v23, v23, v170
    v_add_f32 v24, v24, v171
    v_add_f32 v25, v25, v172
    s_add_u32 m0, s48, 0
    s_xor_b32 s49, s28, 229376
    buffer_load_dwordx4 v3, s[36:39], s49 offen nt lds
    ds_write_b128 v13, v[108:111] offset:45056
    v_mfma_f32_16x16x32_bf16 v[112:115], v[200:203], v[240:243], v[112:115]
    ds_read_b128 v[236:239], v31 offset:8192
    v_mfma_f32_16x16x32_bf16 v[132:135], v[204:207], v[240:243], v[132:135]
    s_add_u32 m0, s48, 1024
    s_xor_b32 s49, s28, 233472
    buffer_load_dwordx4 v3, s[36:39], s49 offen nt lds
    v_mfma_f32_16x16x32_bf16 v[116:119], v[200:203], v[152:155], v[116:119]
    ds_read_b128 v[240:243], v31 offset:9216
    v_mfma_f32_16x16x32_bf16 v[136:139], v[204:207], v[152:155], v[136:139]
    v_mfma_f32_16x16x32_bf16 v[120:123], v[200:203], v[156:159], v[120:123]
    ds_read_b128 v[152:155], v174 offset:5120
    v_mfma_f32_16x16x32_bf16 v[140:143], v[204:207], v[156:159], v[140:143]
    s_waitcnt lgkmcnt(12)
    v_mfma_f32_16x16x32_bf16 v[124:127], v[200:203], v[160:163], v[124:127]
    ds_read_b128 v[156:159], v174 offset:6144
    v_mfma_f32_16x16x32_bf16 v[144:147], v[204:207], v[160:163], v[144:147]
    s_waitcnt lgkmcnt(11)
    v_mfma_f32_16x16x32_bf16 v[128:131], v[200:203], v[164:167], v[128:131]
    ds_read_b128 v[160:163], v174 offset:7168
    v_mfma_f32_16x16x32_bf16 v[148:151], v[204:207], v[164:167], v[148:151]
    s_waitcnt vmcnt(6) lgkmcnt(5)
    s_barrier
    ds_read_b64_tr_b16 v[192:193], v7 offset:2048
    ds_read_b64_tr_b16 v[194:195], v7 offset:4096
    ds_read_b64_tr_b16 v[196:197], v8 offset:2048
    ds_read_b64_tr_b16 v[198:199], v8 offset:4096
    ds_read_b64_tr_b16 v[200:201], v176 offset:2048
    ds_read_b64_tr_b16 v[202:203], v176 offset:4096
    ds_read_b64_tr_b16 v[204:205], v177 offset:2048
    ds_read_b64_tr_b16 v[206:207], v177 offset:4096
    v_mfma_f32_16x16x32_bf16 v[112:115], v[208:211], v[224:227], v[112:115]
    ds_read_b128 v[164:167], v174 offset:8192
    v_mfma_f32_16x16x32_bf16 v[132:135], v[212:215], v[224:227], v[132:135]
    v_mfma_f32_16x16x32_bf16 v[116:119], v[208:211], v[228:231], v[116:119]
    ds_read_b128 v[224:227], v174 offset:9216
    v_mfma_f32_16x16x32_bf16 v[136:139], v[212:215], v[228:231], v[136:139]
    v_mfma_f32_16x16x32_bf16 v[120:123], v[208:211], v[232:235], v[120:123]
    ds_read_b128 v[228:231], v31 offset:10240
    v_mfma_f32_16x16x32_bf16 v[140:143], v[212:215], v[232:235], v[140:143]
    s_waitcnt lgkmcnt(3)
    s_barrier
    s_add_u32 m0, s48, 2048
    s_xor_b32 s49, s28, 237568
    buffer_load_dwordx4 v3, s[36:39], s49 offen nt lds
    v_mfma_f32_16x16x32_bf16 v[124:127], v[208:211], v[236:239], v[124:127]
    ds_read_b128 v[232:235], v31 offset:11264
    v_mfma_f32_16x16x32_bf16 v[144:147], v[212:215], v[236:239], v[144:147]
    s_add_u32 m0, s48, 3072
    s_xor_b32 s49, s28, 241664
    buffer_load_dwordx4 v3, s[36:39], s49 offen nt lds
    v_mfma_f32_16x16x32_bf16 v[128:131], v[208:211], v[240:243], v[128:131]
    ds_read_b128 v[236:239], v31 offset:12288
    v_mfma_f32_16x16x32_bf16 v[148:151], v[212:215], v[240:243], v[148:151]
    s_add_u32 m0, s48, 4096
    s_xor_b32 s49, s28, 49152
    buffer_load_dwordx4 v3, s[36:39], s49 offen nt lds
    s_waitcnt vmcnt(5)
    ds_read_b64_tr_b16 v[32:33], v7 offset:6144
    ds_read_b64_tr_b16 v[34:35], v7 offset:8192
    ds_read_b64_tr_b16 v[36:37], v8 offset:6144
    ds_read_b64_tr_b16 v[38:39], v8 offset:8192
    ds_read_b64_tr_b16 v[40:41], v9 offset:6144
    ds_read_b64_tr_b16 v[42:43], v9 offset:8192
    ds_read_b64_tr_b16 v[44:45], v10 offset:6144
    ds_read_b64_tr_b16 v[46:47], v10 offset:8192
    v_mfma_f32_16x16x32_bf16 v[112:115], v[216:219], v[152:155], v[112:115]
    ds_read_b128 v[240:243], v31 offset:13312
    v_mfma_f32_16x16x32_bf16 v[132:135], v[220:223], v[152:155], v[132:135]
    s_add_u32 m0, s48, 5120
    s_xor_b32 s49, s28, 53248
    buffer_load_dwordx4 v3, s[36:39], s49 offen nt lds
    v_mfma_f32_16x16x32_bf16 v[116:119], v[216:219], v[156:159], v[116:119]
    ds_read_b128 v[152:155], v31 offset:14336
    v_mfma_f32_16x16x32_bf16 v[136:139], v[220:223], v[156:159], v[136:139]
    s_waitcnt lgkmcnt(2)
    v_mfma_f32_16x16x32_bf16 v[120:123], v[216:219], v[160:163], v[120:123]
    ds_read_b128 v[156:159], v174 offset:10240
    v_mfma_f32_16x16x32_bf16 v[140:143], v[220:223], v[160:163], v[140:143]
    s_add_u32 m0, s48, 6144
    s_xor_b32 s49, s28, 57344
    buffer_load_dwordx4 v3, s[36:39], s49 offen nt lds
    v_mfma_f32_16x16x32_bf16 v[124:127], v[216:219], v[164:167], v[124:127]
    ds_read_b128 v[160:163], v174 offset:11264
    v_mfma_f32_16x16x32_bf16 v[144:147], v[220:223], v[164:167], v[144:147]
    s_add_u32 m0, s48, 7168
    s_xor_b32 s49, s28, 61440
    buffer_load_dwordx4 v3, s[36:39], s49 offen nt lds
    v_mfma_f32_16x16x32_bf16 v[128:131], v[216:219], v[224:227], v[128:131]
    ds_read_b128 v[164:167], v174 offset:12288
    v_mfma_f32_16x16x32_bf16 v[148:151], v[220:223], v[224:227], v[148:151]
    s_add_u32 m0, s48, 8192
    s_xor_b32 s49, s28, 114688
    buffer_load_dwordx4 v3, s[36:39], s49 offen nt lds
    s_add_u32 m0, s48, 9216
    s_xor_b32 s49, s28, 118784
    buffer_load_dwordx4 v3, s[36:39], s49 offen nt lds
    s_waitcnt vmcnt(6)
    s_barrier
    ds_read_b64_tr_b16 v[208:209], v7 offset:0
    ds_read_b64_tr_b16 v[210:211], v7 offset:2048
    ds_read_b64_tr_b16 v[212:213], v8 offset:0
    ds_read_b64_tr_b16 v[214:215], v8 offset:2048
    ds_read_b64_tr_b16 v[216:217], v176 offset:0
    ds_read_b64_tr_b16 v[218:219], v176 offset:2048
    ds_read_b64_tr_b16 v[220:221], v177 offset:0
    ds_read_b64_tr_b16 v[222:223], v177 offset:2048
    v_mfma_f32_16x16x32_bf16 v[112:115], v[192:195], v[228:231], v[112:115]
    ds_read_b128 v[224:227], v174 offset:13312
    v_mfma_f32_16x16x32_bf16 v[132:135], v[196:199], v[228:231], v[132:135]
    v_mfma_f32_16x16x32_bf16 v[116:119], v[192:195], v[232:235], v[116:119]
    ds_read_b128 v[228:231], v174 offset:14336
    v_mfma_f32_16x16x32_bf16 v[136:139], v[196:199], v[232:235], v[136:139]
    v_mfma_f32_16x16x32_bf16 v[120:123], v[192:195], v[236:239], v[120:123]
    ds_read_b128 v[232:235], v31 offset:15360
    v_mfma_f32_16x16x32_bf16 v[140:143], v[196:199], v[236:239], v[140:143]
    s_waitcnt lgkmcnt(3)
    s_barrier
    s_add_u32 m0, s48, 0
    s_xor_b32 s49, s28, 122880
    buffer_load_dwordx4 v3, s[36:39], s49 offen nt lds
    v_mfma_f32_16x16x32_bf16 v[124:127], v[192:195], v[240:243], v[124:127]
    ds_read_b128 v[236:239], v31 offset:16384
    v_mfma_f32_16x16x32_bf16 v[144:147], v[196:199], v[240:243], v[144:147]
    s_add_u32 m0, s48, 1024
    s_xor_b32 s49, s28, 126976
    buffer_load_dwordx4 v3, s[36:39], s49 offen nt lds
    v_mfma_f32_16x16x32_bf16 v[128:131], v[192:195], v[152:155], v[128:131]
    ds_read_b128 v[240:243], v31 offset:17408
    v_mfma_f32_16x16x32_bf16 v[148:151], v[196:199], v[152:155], v[148:151]
    s_add_u32 m0, s48, 2048
    s_xor_b32 s49, s28, 180224
    buffer_load_dwordx4 v3, s[36:39], s49 offen nt lds
    v_mfma_f32_16x16x32_bf16 v[112:115], v[200:203], v[156:159], v[112:115]
    ds_read_b128 v[152:155], v31 offset:18432
    v_mfma_f32_16x16x32_bf16 v[132:135], v[204:207], v[156:159], v[132:135]
    s_add_u32 m0, s48, 3072
    s_xor_b32 s49, s28, 184320
    buffer_load_dwordx4 v3, s[36:39], s49 offen nt lds
    v_mfma_f32_16x16x32_bf16 v[116:119], v[200:203], v[160:163], v[116:119]
    ds_read_b128 v[156:159], v31 offset:19456
    v_mfma_f32_16x16x32_bf16 v[136:139], v[204:207], v[160:163], v[136:139]
    v_mfma_f32_16x16x32_bf16 v[120:123], v[200:203], v[164:167], v[120:123]
    ds_read_b128 v[160:163], v174 offset:15360
    v_mfma_f32_16x16x32_bf16 v[140:143], v[204:207], v[164:167], v[140:143]
    s_waitcnt lgkmcnt(7)
    v_mfma_f32_16x16x32_bf16 v[124:127], v[200:203], v[224:227], v[124:127]
    ds_read_b128 v[164:167], v174 offset:16384
    v_mfma_f32_16x16x32_bf16 v[144:147], v[204:207], v[224:227], v[144:147]
    s_waitcnt lgkmcnt(7)
    v_mfma_f32_16x16x32_bf16 v[128:131], v[200:203], v[228:231], v[128:131]
    ds_read_b128 v[224:227], v174 offset:17408
    v_mfma_f32_16x16x32_bf16 v[148:151], v[204:207], v[228:231], v[148:151]
    s_waitcnt vmcnt(6)
    s_barrier
    ds_read_b64_tr_b16 v[192:193], v7 offset:4096
    ds_read_b64_tr_b16 v[194:195], v7 offset:6144
    ds_read_b64_tr_b16 v[196:197], v8 offset:4096
    ds_read_b64_tr_b16 v[198:199], v8 offset:6144
    ds_read_b64_tr_b16 v[200:201], v176 offset:4096
    ds_read_b64_tr_b16 v[202:203], v176 offset:6144
    ds_read_b64_tr_b16 v[204:205], v177 offset:4096
    ds_read_b64_tr_b16 v[206:207], v177 offset:6144
    s_waitcnt lgkmcnt(15)
    v_mfma_f32_16x16x32_bf16 v[112:115], v[208:211], v[232:235], v[112:115]
    ds_read_b128 v[228:231], v174 offset:18432
    v_mfma_f32_16x16x32_bf16 v[132:135], v[212:215], v[232:235], v[132:135]
    s_waitcnt lgkmcnt(15)
    v_mfma_f32_16x16x32_bf16 v[116:119], v[208:211], v[236:239], v[116:119]
    ds_read_b128 v[232:235], v174 offset:19456
    v_mfma_f32_16x16x32_bf16 v[136:139], v[212:215], v[236:239], v[136:139]
    s_waitcnt lgkmcnt(15)
    v_mfma_f32_16x16x32_bf16 v[120:123], v[208:211], v[240:243], v[120:123]
    ds_read_b128 v[236:239], v31 offset:40960
    v_mfma_f32_16x16x32_bf16 v[140:143], v[212:215], v[240:243], v[140:143]
    s_waitcnt lgkmcnt(3)
    s_barrier
    s_add_u32 m0, s48, 4096
    s_xor_b32 s49, s28, 188416
    buffer_load_dwordx4 v3, s[36:39], s49 offen nt lds
    v_mfma_f32_16x16x32_bf16 v[124:127], v[208:211], v[152:155], v[124:127]
    ds_read_b128 v[240:243], v31 offset:41984
    v_mfma_f32_16x16x32_bf16 v[144:147], v[212:215], v[152:155], v[144:147]
    s_add_u32 m0, s48, 5120
    s_xor_b32 s49, s28, 192512
    buffer_load_dwordx4 v3, s[36:39], s49 offen nt lds
    v_mfma_f32_16x16x32_bf16 v[128:131], v[208:211], v[156:159], v[128:131]
    ds_read_b128 v[152:155], v31 offset:43008
    v_mfma_f32_16x16x32_bf16 v[148:151], v[212:215], v[156:159], v[148:151]
    s_add_u32 m0, s48, 6144
    s_xor_b32 s49, s28, 245760
    buffer_load_dwordx4 v3, s[36:39], s49 offen nt lds
    v_mfma_f32_16x16x32_bf16 v[112:115], v[216:219], v[160:163], v[112:115]
    ds_read_b128 v[156:159], v31 offset:44032
    v_mfma_f32_16x16x32_bf16 v[132:135], v[220:223], v[160:163], v[132:135]
    s_add_u32 m0, s48, 7168
    s_xor_b32 s49, s28, 249856
    buffer_load_dwordx4 v3, s[36:39], s49 offen nt lds
    v_mfma_f32_16x16x32_bf16 v[116:119], v[216:219], v[164:167], v[116:119]
    ds_read_b128 v[160:163], v31 offset:45056
    v_mfma_f32_16x16x32_bf16 v[136:139], v[220:223], v[164:167], v[136:139]
    v_mfma_f32_16x16x32_bf16 v[120:123], v[216:219], v[224:227], v[120:123]
    ds_read_b128 v[164:167], v174 offset:40960
    v_mfma_f32_16x16x32_bf16 v[140:143], v[220:223], v[224:227], v[140:143]
    s_waitcnt lgkmcnt(7)
    v_mfma_f32_16x16x32_bf16 v[124:127], v[216:219], v[228:231], v[124:127]
    ds_read_b128 v[224:227], v174 offset:41984
    v_mfma_f32_16x16x32_bf16 v[144:147], v[220:223], v[228:231], v[144:147]
    s_waitcnt lgkmcnt(7)
    v_mfma_f32_16x16x32_bf16 v[128:131], v[216:219], v[232:235], v[128:131]
    ds_read_b128 v[228:231], v174 offset:43008
    v_mfma_f32_16x16x32_bf16 v[148:151], v[220:223], v[232:235], v[148:151]
    s_waitcnt vmcnt(6)
    s_barrier
    ds_read_b64_tr_b16 v[208:209], v7 offset:8192
    ds_read_b64_tr_b16 v[210:211], v7 offset:0
    ds_read_b64_tr_b16 v[212:213], v8 offset:8192
    ds_read_b64_tr_b16 v[214:215], v8 offset:0
    ds_read_b64_tr_b16 v[216:217], v176 offset:8192
    ds_read_b64_tr_b16 v[218:219], v176 offset:0
    ds_read_b64_tr_b16 v[220:221], v177 offset:8192
    ds_read_b64_tr_b16 v[222:223], v177 offset:0
    s_waitcnt lgkmcnt(15)
    v_mfma_f32_16x16x32_bf16 v[112:115], v[192:195], v[236:239], v[112:115]
    ds_read_b128 v[232:235], v174 offset:44032
    v_and_b32 v2, 15, v1
    v_lshlrev_b32 v2, 5, v2
    v_add_u32 v2, 81920, v2
    v_mfma_f32_16x16x32_bf16 v[132:135], v[196:199], v[236:239], v[132:135]
    s_lshl_b32 s51, s9, 9
    v_add_u32 v173, s51, v2
    ds_write_b64 v173, v[22:23] offset:8
    s_waitcnt lgkmcnt(15)
    v_mfma_f32_16x16x32_bf16 v[116:119], v[192:195], v[240:243], v[116:119]
    ds_read_b128 v[236:239], v174 offset:45056
    ds_write_b64 v173, v[24:25] offset:16
    ds_write_b32 v173, v21 offset:4
    v_mfma_f32_16x16x32_bf16 v[136:139], v[196:199], v[240:243], v[136:139]
    v_mfma_f32_16x16x32_bf16 v[120:123], v[192:195], v[152:155], v[120:123]
    ds_read_b128 v[240:243], v31 offset:46080
    v_mfma_f32_16x16x32_bf16 v[140:143], v[196:199], v[152:155], v[140:143]
    s_waitcnt lgkmcnt(6)
    s_barrier
    s_add_u32 m0, s48, 8192
    s_xor_b32 s49, s28, 253952
    buffer_load_dwordx4 v3, s[36:39], s49 offen nt lds
    v_mfma_f32_16x16x32_bf16 v[124:127], v[192:195], v[156:159], v[124:127]
    ds_read_b128 v[152:155], v31 offset:47104
    v_mfma_f32_16x16x32_bf16 v[144:147], v[196:199], v[156:159], v[144:147]
    s_add_u32 m0, s48, 9216
    s_xor_b32 s49, s28, 258048
    buffer_load_dwordx4 v3, s[36:39], s49 offen nt lds
    v_mfma_f32_16x16x32_bf16 v[128:131], v[192:195], v[160:163], v[128:131]
    ds_read_b128 v[156:159], v31 offset:48128
    v_mfma_f32_16x16x32_bf16 v[148:151], v[196:199], v[160:163], v[148:151]
    s_add_u32 m0, s48, 0
    s_add_u32 s49, s13, 0
    buffer_load_dwordx4 v4, s[40:43], s49 offen lds
    v_mfma_f32_16x16x32_bf16 v[112:115], v[200:203], v[164:167], v[112:115]
    ds_read_b128 v[160:163], v31 offset:49152
    v_mfma_f32_16x16x32_bf16 v[132:135], v[204:207], v[164:167], v[132:135]
    s_add_u32 m0, s48, 1024
    s_add_u32 s49, s13, 7168
    buffer_load_dwordx4 v4, s[40:43], s49 offen lds
    v_mfma_f32_16x16x32_bf16 v[116:119], v[200:203], v[224:227], v[116:119]
    ds_read_b128 v[164:167], v31 offset:50176
    v_mfma_f32_16x16x32_bf16 v[136:139], v[204:207], v[224:227], v[136:139]
    v_mfma_f32_16x16x32_bf16 v[120:123], v[200:203], v[228:231], v[120:123]
    ds_read_b128 v[224:227], v174 offset:46080
    v_mfma_f32_16x16x32_bf16 v[140:143], v[204:207], v[228:231], v[140:143]
    s_waitcnt lgkmcnt(10)
    v_mfma_f32_16x16x32_bf16 v[124:127], v[200:203], v[232:235], v[124:127]
    ds_read_b128 v[228:231], v174 offset:47104
    v_mfma_f32_16x16x32_bf16 v[144:147], v[204:207], v[232:235], v[144:147]
    s_waitcnt lgkmcnt(9)
    v_mfma_f32_16x16x32_bf16 v[128:131], v[200:203], v[236:239], v[128:131]
    ds_read_b128 v[232:235], v174 offset:48128
    v_mfma_f32_16x16x32_bf16 v[148:151], v[204:207], v[236:239], v[148:151]
    s_waitcnt vmcnt(6) lgkmcnt(8)
    s_barrier
    ds_read_b64_tr_b16 v[192:193], v7 offset:2048
    ds_read_b64_tr_b16 v[194:195], v7 offset:4096
    ds_read_b64_tr_b16 v[196:197], v8 offset:2048
    ds_read_b64_tr_b16 v[198:199], v8 offset:4096
    ds_read_b64_tr_b16 v[200:201], v176 offset:2048
    ds_read_b64_tr_b16 v[202:203], v176 offset:4096
    ds_read_b64_tr_b16 v[204:205], v177 offset:2048
    ds_read_b64_tr_b16 v[206:207], v177 offset:4096
    s_waitcnt lgkmcnt(15)
    ds_read_b128 v[180:183], v2 offset:0
    ds_read_b64 v[188:189], v2 offset:16
    ds_read_b128 v[184:187], v2 offset:512
    ds_read_b64 v[190:191], v2 offset:528
    v_mfma_f32_16x16x32_bf16 v[112:115], v[208:211], v[240:243], v[112:115]
    ds_read_b128 v[236:239], v174 offset:49152
    v_mfma_f32_16x16x32_bf16 v[132:135], v[212:215], v[240:243], v[132:135]
    s_waitcnt lgkmcnt(15)
    v_mfma_f32_16x16x32_bf16 v[116:119], v[208:211], v[152:155], v[116:119]
    ds_read_b128 v[240:243], v174 offset:50176
    v_mfma_f32_16x16x32_bf16 v[136:139], v[212:215], v[152:155], v[136:139]
    v_mfma_f32_16x16x32_bf16 v[120:123], v[208:211], v[156:159], v[120:123]
    ds_read_b128 v[152:155], v31 offset:51200
    v_mfma_f32_16x16x32_bf16 v[140:143], v[212:215], v[156:159], v[140:143]
    s_waitcnt lgkmcnt(7)
    s_barrier
    s_add_u32 m0, s48, 2048
    s_add_u32 s49, s13, 14336
    buffer_load_dwordx4 v4, s[40:43], s49 offen lds
    s_waitcnt lgkmcnt(3)
    v_add_f32 v21, v181, v185
    v_add_f32 v22, v182, v186
    v_add_f32 v23, v183, v187
    v_add_f32 v24, v188, v190
    v_add_f32 v25, v189, v191
    ds_read_b128 v[180:183], v2 offset:1024
    ds_read_b64 v[188:189], v2 offset:1040
    ds_read_b128 v[184:187], v2 offset:1536
    ds_read_b64 v[190:191], v2 offset:1552
    v_mfma_f32_16x16x32_bf16 v[124:127], v[208:211], v[160:163], v[124:127]
    ds_read_b128 v[156:159], v31 offset:52224
    v_mfma_f32_16x16x32_bf16 v[144:147], v[212:215], v[160:163], v[144:147]
    s_add_u32 m0, s48, 3072
    s_add_u32 s49, s13, 21504
    buffer_load_dwordx4 v4, s[40:43], s49 offen lds
    v_mfma_f32_16x16x32_bf16 v[128:131], v[208:211], v[164:167], v[128:131]
    ds_read_b128 v[160:163], v31 offset:53248
    v_mfma_f32_16x16x32_bf16 v[148:151], v[212:215], v[164:167], v[148:151]
    s_add_u32 m0, s48, 4096
    s_add_u32 s49, s14, 0
    buffer_load_dwordx4 v4, s[40:43], s49 offen lds
    s_waitcnt lgkmcnt(2)
    v_add_f32 v21, v21, v181
    v_add_f32 v21, v21, v185
    v_add_f32 v22, v22, v182
    v_add_f32 v22, v22, v186
    v_add_f32 v23, v23, v183
    v_add_f32 v23, v23, v187
    v_add_f32 v24, v24, v188
    v_add_f32 v24, v24, v190
    v_add_f32 v25, v25, v189
    v_add_f32 v25, v25, v191
    ds_read_b128 v[180:183], v2 offset:2048
    ds_read_b64 v[188:189], v2 offset:2064
    ds_read_b128 v[184:187], v2 offset:2560
    ds_read_b64 v[190:191], v2 offset:2576
    v_mfma_f32_16x16x32_bf16 v[112:115], v[216:219], v[224:227], v[112:115]
    ds_read_b128 v[164:167], v31 offset:54272
    v_mfma_f32_16x16x32_bf16 v[132:135], v[220:223], v[224:227], v[132:135]
    s_add_u32 m0, s48, 5120
    s_add_u32 s49, s14, 7168
    buffer_load_dwordx4 v4, s[40:43], s49 offen lds
    v_mfma_f32_16x16x32_bf16 v[116:119], v[216:219], v[228:231], v[116:119]
    ds_read_b128 v[224:227], v31 offset:55296
    v_mfma_f32_16x16x32_bf16 v[136:139], v[220:223], v[228:231], v[136:139]
    v_mfma_f32_16x16x32_bf16 v[120:123], v[216:219], v[232:235], v[120:123]
    ds_read_b128 v[228:231], v174 offset:51200
    v_mfma_f32_16x16x32_bf16 v[140:143], v[220:223], v[232:235], v[140:143]
    s_waitcnt lgkmcnt(3)
    v_add_f32 v21, v21, v181
    v_add_f32 v21, v21, v185
    v_add_f32 v22, v22, v182
    v_add_f32 v22, v22, v186
    v_add_f32 v23, v23, v183
    v_add_f32 v23, v23, v187
    v_add_f32 v24, v24, v188
    v_add_f32 v24, v24, v190
    v_add_f32 v25, v25, v189
    v_add_f32 v25, v25, v191
    ds_read_b128 v[180:183], v2 offset:3072
    ds_read_b64 v[188:189], v2 offset:3088
    ds_read_b128 v[184:187], v2 offset:3584
    ds_read_b64 v[190:191], v2 offset:3600
    v_mfma_f32_16x16x32_bf16 v[124:127], v[216:219], v[236:239], v[124:127]
    ds_read_b128 v[232:235], v174 offset:52224
    v_mfma_f32_16x16x32_bf16 v[144:147], v[220:223], v[236:239], v[144:147]
    v_mfma_f32_16x16x32_bf16 v[128:131], v[216:219], v[240:243], v[128:131]
    ds_read_b128 v[236:239], v174 offset:53248
    v_mfma_f32_16x16x32_bf16 v[148:151], v[220:223], v[240:243], v[148:151]
    s_waitcnt vmcnt(6) lgkmcnt(2)
    s_barrier
    ds_read_b64_tr_b16 v[208:209], v7 offset:6144
    ds_read_b64_tr_b16 v[210:211], v7 offset:8192
    ds_read_b64_tr_b16 v[212:213], v8 offset:6144
    ds_read_b64_tr_b16 v[214:215], v8 offset:8192
    ds_read_b64_tr_b16 v[216:217], v176 offset:6144
    ds_read_b64_tr_b16 v[218:219], v176 offset:8192
    ds_read_b64_tr_b16 v[220:221], v177 offset:6144
    ds_read_b64_tr_b16 v[222:223], v177 offset:8192
    v_mfma_f32_16x16x32_bf16 v[112:115], v[192:195], v[152:155], v[112:115]
    ds_read_b128 v[240:243], v174 offset:54272
    v_add_f32 v21, v21, v181
    v_add_f32 v21, v21, v185
    v_rcp_f32 v21, v21
    v_mfma_f32_16x16x32_bf16 v[132:135], v[196:199], v[152:155], v[132:135]
    v_add_f32 v22, v22, v182
    v_add_f32 v22, v22, v186
    v_rcp_f32 v22, v22
    v_mfma_f32_16x16x32_bf16 v[116:119], v[192:195], v[156:159], v[116:119]
    ds_read_b128 v[152:155], v174 offset:55296
    v_add_f32 v23, v23, v183
    v_add_f32 v23, v23, v187
    v_rcp_f32 v23, v23
    v_mfma_f32_16x16x32_bf16 v[136:139], v[196:199], v[156:159], v[136:139]
    v_add_f32 v24, v24, v188
    v_add_f32 v24, v24, v190
    v_rcp_f32 v24, v24
    v_mfma_f32_16x16x32_bf16 v[120:123], v[192:195], v[160:163], v[120:123]
    ds_read_b128 v[156:159], v31 offset:56320
    v_add_f32 v25, v25, v189
    v_add_f32 v25, v25, v191
    v_rcp_f32 v25, v25
    v_mfma_f32_16x16x32_bf16 v[140:143], v[196:199], v[160:163], v[140:143]
    s_waitcnt lgkmcnt(3)
    s_barrier
    s_add_u32 m0, s48, 6144
    s_add_u32 s49, s14, 14336
    buffer_load_dwordx4 v4, s[40:43], s49 offen lds
    v_mfma_f32_16x16x32_bf16 v[124:127], v[192:195], v[164:167], v[124:127]
    ds_read_b128 v[160:163], v31 offset:57344
    v_mfma_f32_16x16x32_bf16 v[144:147], v[196:199], v[164:167], v[144:147]
    s_add_u32 m0, s48, 7168
    s_add_u32 s49, s14, 21504
    buffer_load_dwordx4 v4, s[40:43], s49 offen lds
    v_mfma_f32_16x16x32_bf16 v[128:131], v[192:195], v[224:227], v[128:131]
    ds_read_b128 v[164:167], v31 offset:58368
    v_mfma_f32_16x16x32_bf16 v[148:151], v[196:199], v[224:227], v[148:151]
    s_add_u32 m0, s48, 8192
    s_add_u32 s49, s15, 0
    buffer_load_dwordx4 v4, s[40:43], s49 offen lds
    v_mfma_f32_16x16x32_bf16 v[112:115], v[200:203], v[228:231], v[112:115]
    ds_read_b128 v[224:227], v31 offset:59392
    v_mfma_f32_16x16x32_bf16 v[132:135], v[204:207], v[228:231], v[132:135]
    s_add_u32 m0, s48, 9216
    s_add_u32 s49, s15, 7168
    buffer_load_dwordx4 v4, s[40:43], s49 offen lds
    v_mfma_f32_16x16x32_bf16 v[116:119], v[200:203], v[232:235], v[116:119]
    ds_read_b128 v[228:231], v31 offset:60416
    v_mfma_f32_16x16x32_bf16 v[136:139], v[204:207], v[232:235], v[136:139]
    v_mfma_f32_16x16x32_bf16 v[120:123], v[200:203], v[236:239], v[120:123]
    ds_read_b128 v[232:235], v174 offset:56320
    v_mfma_f32_16x16x32_bf16 v[140:143], v[204:207], v[236:239], v[140:143]
    s_waitcnt lgkmcnt(7)
    v_mfma_f32_16x16x32_bf16 v[124:127], v[200:203], v[240:243], v[124:127]
    ds_read_b128 v[236:239], v174 offset:57344
    v_mfma_f32_16x16x32_bf16 v[144:147], v[204:207], v[240:243], v[144:147]
    s_waitcnt lgkmcnt(7)
    v_mfma_f32_16x16x32_bf16 v[128:131], v[200:203], v[152:155], v[128:131]
    ds_read_b128 v[240:243], v174 offset:58368
    v_mfma_f32_16x16x32_bf16 v[148:151], v[204:207], v[152:155], v[148:151]
    s_waitcnt lgkmcnt(7)
    v_mfma_f32_16x16x32_bf16 v[112:115], v[208:211], v[156:159], v[112:115]
    ds_read_b128 v[152:155], v174 offset:59392
    v_mfma_f32_16x16x32_bf16 v[132:135], v[212:215], v[156:159], v[132:135]
    s_waitcnt lgkmcnt(7)
    v_mfma_f32_16x16x32_bf16 v[116:119], v[208:211], v[160:163], v[116:119]
    ds_read_b128 v[156:159], v174 offset:60416
    v_mfma_f32_16x16x32_bf16 v[136:139], v[212:215], v[160:163], v[136:139]
    s_waitcnt lgkmcnt(7)
    v_mfma_f32_16x16x32_bf16 v[120:123], v[208:211], v[164:167], v[120:123]
    v_mfma_f32_16x16x32_bf16 v[140:143], v[212:215], v[164:167], v[140:143]
    s_waitcnt lgkmcnt(6)
    v_mfma_f32_16x16x32_bf16 v[124:127], v[208:211], v[224:227], v[124:127]
    v_mfma_f32_16x16x32_bf16 v[144:147], v[212:215], v[224:227], v[144:147]
    s_waitcnt lgkmcnt(5)
    v_mfma_f32_16x16x32_bf16 v[128:131], v[208:211], v[228:231], v[128:131]
    v_mfma_f32_16x16x32_bf16 v[148:151], v[212:215], v[228:231], v[148:151]
    s_waitcnt lgkmcnt(4)
    v_mfma_f32_16x16x32_bf16 v[112:115], v[216:219], v[232:235], v[112:115]
    v_mfma_f32_16x16x32_bf16 v[132:135], v[220:223], v[232:235], v[132:135]
    s_waitcnt lgkmcnt(3)
    v_mfma_f32_16x16x32_bf16 v[116:119], v[216:219], v[236:239], v[116:119]
    v_mfma_f32_16x16x32_bf16 v[136:139], v[220:223], v[236:239], v[136:139]
    s_waitcnt lgkmcnt(2)
    v_mfma_f32_16x16x32_bf16 v[120:123], v[216:219], v[240:243], v[120:123]
    v_mfma_f32_16x16x32_bf16 v[140:143], v[220:223], v[240:243], v[140:143]
    s_waitcnt lgkmcnt(1)
    v_mfma_f32_16x16x32_bf16 v[124:127], v[216:219], v[152:155], v[124:127]
    v_mfma_f32_16x16x32_bf16 v[144:147], v[220:223], v[152:155], v[144:147]
    s_waitcnt lgkmcnt(0)
    v_mfma_f32_16x16x32_bf16 v[128:131], v[216:219], v[156:159], v[128:131]
    v_mfma_f32_16x16x32_bf16 v[148:151], v[220:223], v[156:159], v[148:151]
    s_mul_i32 s49, s9, 5120
    v_add_u32 v14, s49, v11
    v_mul_f32 v112, v112, v21
    v_mul_f32 v113, v113, v21
    v_mul_f32 v114, v114, v21
    v_mul_f32 v115, v115, v21
    v_cvt_pk_bf16_f32 v224, v112, v113
    v_cvt_pk_bf16_f32 v225, v114, v115
    v_mul_f32 v132, v132, v21
    v_mul_f32 v133, v133, v21
    v_mul_f32 v134, v134, v21
    v_mul_f32 v135, v135, v21
    v_cvt_pk_bf16_f32 v226, v132, v133
    v_cvt_pk_bf16_f32 v227, v134, v135
    ds_write_b128 v14, v[224:227] offset:0
    v_mul_f32 v116, v116, v22
    v_mul_f32 v117, v117, v22
    v_mul_f32 v118, v118, v22
    v_mul_f32 v119, v119, v22
    v_cvt_pk_bf16_f32 v228, v116, v117
    v_cvt_pk_bf16_f32 v229, v118, v119
    v_mul_f32 v136, v136, v22
    v_mul_f32 v137, v137, v22
    v_mul_f32 v138, v138, v22
    v_mul_f32 v139, v139, v22
    v_cvt_pk_bf16_f32 v230, v136, v137
    v_cvt_pk_bf16_f32 v231, v138, v139
    ds_write_b128 v14, v[228:231] offset:1024
    v_mul_f32 v120, v120, v23
    v_mul_f32 v121, v121, v23
    v_mul_f32 v122, v122, v23
    v_mul_f32 v123, v123, v23
    v_cvt_pk_bf16_f32 v232, v120, v121
    v_cvt_pk_bf16_f32 v233, v122, v123
    v_mul_f32 v140, v140, v23
    v_mul_f32 v141, v141, v23
    v_mul_f32 v142, v142, v23
    v_mul_f32 v143, v143, v23
    v_cvt_pk_bf16_f32 v234, v140, v141
    v_cvt_pk_bf16_f32 v235, v142, v143
    ds_write_b128 v14, v[232:235] offset:2048
    v_mul_f32 v124, v124, v24
    v_mul_f32 v125, v125, v24
    v_mul_f32 v126, v126, v24
    v_mul_f32 v127, v127, v24
    v_cvt_pk_bf16_f32 v236, v124, v125
    v_cvt_pk_bf16_f32 v237, v126, v127
    v_mul_f32 v144, v144, v24
    v_mul_f32 v145, v145, v24
    v_mul_f32 v146, v146, v24
    v_mul_f32 v147, v147, v24
    v_cvt_pk_bf16_f32 v238, v144, v145
    v_cvt_pk_bf16_f32 v239, v146, v147
    ds_write_b128 v14, v[236:239] offset:3072
    v_mul_f32 v128, v128, v25
    v_mul_f32 v129, v129, v25
    v_mul_f32 v130, v130, v25
    v_mul_f32 v131, v131, v25
    v_cvt_pk_bf16_f32 v240, v128, v129
    v_cvt_pk_bf16_f32 v241, v130, v131
    v_mul_f32 v148, v148, v25
    v_mul_f32 v149, v149, v25
    v_mul_f32 v150, v150, v25
    v_mul_f32 v151, v151, v25
    v_cvt_pk_bf16_f32 v242, v148, v149
    v_cvt_pk_bf16_f32 v243, v150, v151
    ds_write_b128 v14, v[240:243] offset:4096
    s_waitcnt vmcnt(6)
    ds_read_b64_tr_b16 v[48:49], v7 offset:0
    ds_read_b64_tr_b16 v[50:51], v7 offset:2048
    ds_read_b64_tr_b16 v[52:53], v8 offset:0
    ds_read_b64_tr_b16 v[54:55], v8 offset:2048
    ds_read_b64_tr_b16 v[56:57], v9 offset:0
    ds_read_b64_tr_b16 v[58:59], v9 offset:2048
    ds_read_b64_tr_b16 v[60:61], v10 offset:0
    ds_read_b64_tr_b16 v[62:63], v10 offset:2048
    s_waitcnt vmcnt(2)
    ds_read_b64_tr_b16 v[64:65], v7 offset:4096
    ds_read_b64_tr_b16 v[66:67], v7 offset:6144
    ds_read_b64_tr_b16 v[68:69], v8 offset:4096
    ds_read_b64_tr_b16 v[70:71], v8 offset:6144
    ds_read_b64_tr_b16 v[72:73], v9 offset:4096
    ds_read_b64_tr_b16 v[74:75], v9 offset:6144
    ds_read_b64_tr_b16 v[76:77], v10 offset:4096
    ds_read_b64_tr_b16 v[78:79], v10 offset:6144
    s_waitcnt lgkmcnt(8)
    s_waitcnt lgkmcnt(0)
    s_add_u32 m0, s48, 0
    s_add_u32 s49, s15, 14336
    buffer_load_dwordx4 v4, s[40:43], s49 offen lds
    s_add_u32 m0, s48, 1024
    s_add_u32 s49, s15, 21504
    buffer_load_dwordx4 v4, s[40:43], s49 offen lds
    s_add_u32 m0, s48, 2048
    s_add_u32 s49, s16, 0
    buffer_load_dwordx4 v4, s[40:43], s49 offen lds
    s_add_u32 m0, s48, 3072
    s_add_u32 s49, s16, 7168
    buffer_load_dwordx4 v4, s[40:43], s49 offen lds
    s_add_u32 m0, s48, 4096
    s_add_u32 s49, s16, 14336
    buffer_load_dwordx4 v4, s[40:43], s49 offen lds
    s_add_u32 m0, s48, 5120
    s_add_u32 s49, s16, 21504
    buffer_load_dwordx4 v4, s[40:43], s49 offen lds
    s_add_u32 m0, s48, 6144
    s_add_u32 s49, s17, 0
    buffer_load_dwordx4 v4, s[40:43], s49 offen lds
    s_add_u32 m0, s48, 7168
    s_add_u32 s49, s17, 7168
    buffer_load_dwordx4 v4, s[40:43], s49 offen lds
    s_lshl_b32 s49, s11, 10
    v_add_u32 v2, s49, v0
    v_xor_b32 v3, 0x400, v2
    s_mul_i32 s67, s8, 71680
    s_add_u32 s67, s67, s48
    s_add_u32 s49, s6, 0
    s_and_b32 s49, s49, 7
    s_mul_i32 s24, s49, 5120
    s_add_u32 s49, s6, 1
    s_and_b32 s49, s49, 7
    s_mul_i32 s25, s49, 5120
    s_add_u32 s49, s6, 2
    s_and_b32 s49, s49, 7
    s_mul_i32 s26, s49, 5120
    s_add_u32 s49, s6, 3
    s_and_b32 s49, s49, 7
    s_mul_i32 s27, s49, 5120
    s_add_u32 s49, s6, 4
    s_and_b32 s49, s49, 7
    s_mul_i32 s28, s49, 5120
    s_add_u32 s49, s6, 5
    s_and_b32 s49, s49, 7
    s_mul_i32 s29, s49, 5120
    s_add_u32 s49, s6, 6
    s_and_b32 s49, s49, 7
    s_mul_i32 s30, s49, 5120
    s_add_u32 s49, s6, 7
    s_and_b32 s49, s49, 7
    s_mul_i32 s31, s49, 5120
    v_add_u32 v5, s24, v11
    s_barrier
    s_cmp_eq_u32 s9, 7
    s_cbranch_scc1 L_w7
    ds_read_b128 v[224:227], v5 offset:0
    ds_read_b128 v[228:231], v5 offset:1024
    ds_read_b128 v[232:235], v5 offset:2048
    ds_read_b128 v[236:239], v5 offset:3072
    s_waitcnt lgkmcnt(3)
    v_mfma_f32_16x16x32_bf16 v[112:115], v[32:35], v[224:227], 0
    ds_read_b128 v[240:243], v5 offset:4096
    v_mfma_f32_16x16x32_bf16 v[132:135], v[36:39], v[224:227], 0
    s_waitcnt lgkmcnt(3)
    v_mfma_f32_16x16x32_bf16 v[116:119], v[32:35], v[228:231], 0
    v_add_u32 v6, s25, v11
    ds_read_b128 v[224:227], v6 offset:0
    v_mfma_f32_16x16x32_bf16 v[136:139], v[36:39], v[228:231], 0
    s_waitcnt lgkmcnt(3)
    v_mfma_f32_16x16x32_bf16 v[120:123], v[32:35], v[232:235], 0
    ds_read_b128 v[228:231], v6 offset:1024
    v_mfma_f32_16x16x32_bf16 v[140:143], v[36:39], v[232:235], 0
    s_waitcnt lgkmcnt(3)
    v_mfma_f32_16x16x32_bf16 v[124:127], v[32:35], v[236:239], 0
    ds_read_b128 v[232:235], v6 offset:2048
    v_mfma_f32_16x16x32_bf16 v[144:147], v[36:39], v[236:239], 0
    s_waitcnt lgkmcnt(3)
    v_mfma_f32_16x16x32_bf16 v[128:131], v[32:35], v[240:243], 0
    ds_read_b128 v[236:239], v6 offset:3072
    v_mfma_f32_16x16x32_bf16 v[148:151], v[36:39], v[240:243], 0
    s_waitcnt vmcnt(6)
    ds_read_b64_tr_b16 v[80:81], v7 offset:8192
    ds_read_b64_tr_b16 v[82:83], v7 offset:0
    ds_read_b64_tr_b16 v[84:85], v8 offset:8192
    ds_read_b64_tr_b16 v[86:87], v8 offset:0
    ds_read_b64_tr_b16 v[88:89], v9 offset:8192
    ds_read_b64_tr_b16 v[90:91], v9 offset:0
    ds_read_b64_tr_b16 v[92:93], v10 offset:8192
    ds_read_b64_tr_b16 v[94:95], v10 offset:0
    s_waitcnt lgkmcnt(0)
    s_add_u32 m0, s48, 8192
    s_add_u32 s49, s17, 14336
    buffer_load_dwordx4 v4, s[40:43], s49 offen lds
    s_add_u32 m0, s48, 9216
    s_add_u32 s49, s17, 21504
    buffer_load_dwordx4 v4, s[40:43], s49 offen lds
    s_add_u32 m0, s48, 0
    s_add_u32 s49, s18, 0
    buffer_load_dwordx4 v4, s[40:43], s49 offen lds
    s_add_u32 m0, s48, 1024
    s_add_u32 s49, s18, 7168
    buffer_load_dwordx4 v4, s[40:43], s49 offen lds
    v_mfma_f32_16x16x32_bf16 v[112:115], v[48:51], v[224:227], v[112:115]
    ds_read_b128 v[240:243], v6 offset:4096
    v_mfma_f32_16x16x32_bf16 v[132:135], v[52:55], v[224:227], v[132:135]
    v_mfma_f32_16x16x32_bf16 v[116:119], v[48:51], v[228:231], v[116:119]
    v_add_u32 v5, s26, v11
    ds_read_b128 v[224:227], v5 offset:0
    v_mfma_f32_16x16x32_bf16 v[136:139], v[52:55], v[228:231], v[136:139]
    v_mfma_f32_16x16x32_bf16 v[120:123], v[48:51], v[232:235], v[120:123]
    ds_read_b128 v[228:231], v5 offset:1024
    v_mfma_f32_16x16x32_bf16 v[140:143], v[52:55], v[232:235], v[140:143]
    v_mfma_f32_16x16x32_bf16 v[124:127], v[48:51], v[236:239], v[124:127]
    ds_read_b128 v[232:235], v5 offset:2048
    v_mfma_f32_16x16x32_bf16 v[144:147], v[52:55], v[236:239], v[144:147]
    s_waitcnt lgkmcnt(3)
    v_mfma_f32_16x16x32_bf16 v[128:131], v[48:51], v[240:243], v[128:131]
    ds_read_b128 v[236:239], v5 offset:3072
    v_mfma_f32_16x16x32_bf16 v[148:151], v[52:55], v[240:243], v[148:151]
    s_waitcnt vmcnt(6)
    ds_read_b64_tr_b16 v[96:97], v7 offset:2048
    ds_read_b64_tr_b16 v[98:99], v7 offset:4096
    ds_read_b64_tr_b16 v[100:101], v8 offset:2048
    ds_read_b64_tr_b16 v[102:103], v8 offset:4096
    ds_read_b64_tr_b16 v[104:105], v9 offset:2048
    ds_read_b64_tr_b16 v[106:107], v9 offset:4096
    ds_read_b64_tr_b16 v[108:109], v10 offset:2048
    ds_read_b64_tr_b16 v[110:111], v10 offset:4096
    s_waitcnt lgkmcnt(0)
    s_add_u32 m0, s48, 2048
    s_add_u32 s49, s18, 14336
    buffer_load_dwordx4 v4, s[40:43], s49 offen lds
    s_add_u32 m0, s48, 3072
    s_add_u32 s49, s18, 21504
    buffer_load_dwordx4 v4, s[40:43], s49 offen lds
    s_add_u32 m0, s48, 4096
    s_add_u32 s49, s19, 0
    buffer_load_dwordx4 v4, s[40:43], s49 offen lds
    s_add_u32 m0, s48, 5120
    s_add_u32 s49, s19, 7168
    buffer_load_dwordx4 v4, s[40:43], s49 offen lds
    v_mfma_f32_16x16x32_bf16 v[112:115], v[64:67], v[224:227], v[112:115]
    ds_read_b128 v[240:243], v5 offset:4096
    v_mfma_f32_16x16x32_bf16 v[132:135], v[68:71], v[224:227], v[132:135]
    v_mfma_f32_16x16x32_bf16 v[116:119], v[64:67], v[228:231], v[116:119]
    v_add_u32 v6, s27, v11
    ds_read_b128 v[224:227], v6 offset:0
    v_mfma_f32_16x16x32_bf16 v[136:139], v[68:71], v[228:231], v[136:139]
    v_mfma_f32_16x16x32_bf16 v[120:123], v[64:67], v[232:235], v[120:123]
    ds_read_b128 v[228:231], v6 offset:1024
    v_mfma_f32_16x16x32_bf16 v[140:143], v[68:71], v[232:235], v[140:143]
    v_mfma_f32_16x16x32_bf16 v[124:127], v[64:67], v[236:239], v[124:127]
    ds_read_b128 v[232:235], v6 offset:2048
    v_mfma_f32_16x16x32_bf16 v[144:147], v[68:71], v[236:239], v[144:147]
    s_waitcnt lgkmcnt(3)
    v_mfma_f32_16x16x32_bf16 v[128:131], v[64:67], v[240:243], v[128:131]
    ds_read_b128 v[236:239], v6 offset:3072
    v_mfma_f32_16x16x32_bf16 v[148:151], v[68:71], v[240:243], v[148:151]
    s_waitcnt lgkmcnt(3)
    v_mfma_f32_16x16x32_bf16 v[112:115], v[80:83], v[224:227], v[112:115]
    ds_read_b128 v[240:243], v6 offset:4096
    v_mfma_f32_16x16x32_bf16 v[132:135], v[84:87], v[224:227], v[132:135]
    s_waitcnt lgkmcnt(3)
    v_mfma_f32_16x16x32_bf16 v[116:119], v[80:83], v[228:231], v[116:119]
    v_add_u32 v5, s28, v11
    ds_read_b128 v[224:227], v5 offset:0
    v_mfma_f32_16x16x32_bf16 v[136:139], v[84:87], v[228:231], v[136:139]
    s_waitcnt lgkmcnt(3)
    v_mfma_f32_16x16x32_bf16 v[120:123], v[80:83], v[232:235], v[120:123]
    ds_read_b128 v[228:231], v5 offset:1024
    v_mfma_f32_16x16x32_bf16 v[140:143], v[84:87], v[232:235], v[140:143]
    s_waitcnt lgkmcnt(3)
    v_mfma_f32_16x16x32_bf16 v[124:127], v[80:83], v[236:239], v[124:127]
    ds_read_b128 v[232:235], v5 offset:2048
    v_mfma_f32_16x16x32_bf16 v[144:147], v[84:87], v[236:239], v[144:147]
    s_waitcnt lgkmcnt(3)
    v_mfma_f32_16x16x32_bf16 v[128:131], v[80:83], v[240:243], v[128:131]
    ds_read_b128 v[236:239], v5 offset:3072
    v_mfma_f32_16x16x32_bf16 v[148:151], v[84:87], v[240:243], v[148:151]
    s_waitcnt vmcnt(6)
    ds_read_b64_tr_b16 v[244:245], v7 offset:6144
    ds_read_b64_tr_b16 v[246:247], v7 offset:8192
    ds_read_b64_tr_b16 v[248:249], v8 offset:6144
    ds_read_b64_tr_b16 v[250:251], v8 offset:8192
    ds_read_b64_tr_b16 v[252:253], v9 offset:6144
    ds_read_b64_tr_b16 v[254:255], v9 offset:8192
    ds_read_b64_tr_b16 v[16:17], v10 offset:6144
    ds_read_b64_tr_b16 v[18:19], v10 offset:8192
    s_waitcnt lgkmcnt(0)
    s_add_u32 m0, s48, 6144
    s_add_u32 s49, s19, 14336
    buffer_load_dwordx4 v4, s[40:43], s49 offen lds
    s_add_u32 m0, s48, 7168
    s_add_u32 s49, s19, 21504
    buffer_load_dwordx4 v4, s[40:43], s49 offen lds
    v_mfma_f32_16x16x32_bf16 v[112:115], v[96:99], v[224:227], v[112:115]
    ds_read_b128 v[240:243], v5 offset:4096
    v_mfma_f32_16x16x32_bf16 v[132:135], v[100:103], v[224:227], v[132:135]
    v_mfma_f32_16x16x32_bf16 v[116:119], v[96:99], v[228:231], v[116:119]
    v_add_u32 v6, s29, v11
    ds_read_b128 v[224:227], v6 offset:0
    v_mfma_f32_16x16x32_bf16 v[136:139], v[100:103], v[228:231], v[136:139]
    v_mfma_f32_16x16x32_bf16 v[120:123], v[96:99], v[232:235], v[120:123]
    ds_read_b128 v[228:231], v6 offset:1024
    v_mfma_f32_16x16x32_bf16 v[140:143], v[100:103], v[232:235], v[140:143]
    v_mfma_f32_16x16x32_bf16 v[124:127], v[96:99], v[236:239], v[124:127]
    ds_read_b128 v[232:235], v6 offset:2048
    v_mfma_f32_16x16x32_bf16 v[144:147], v[100:103], v[236:239], v[144:147]
    s_waitcnt lgkmcnt(3)
    v_mfma_f32_16x16x32_bf16 v[128:131], v[96:99], v[240:243], v[128:131]
    ds_read_b128 v[236:239], v6 offset:3072
    v_mfma_f32_16x16x32_bf16 v[148:151], v[100:103], v[240:243], v[148:151]
    s_waitcnt vmcnt(4)
    ds_read_b64_tr_b16 v[192:193], v7 offset:0
    ds_read_b64_tr_b16 v[194:195], v7 offset:2048
    ds_read_b64_tr_b16 v[196:197], v8 offset:0
    ds_read_b64_tr_b16 v[198:199], v8 offset:2048
    ds_read_b64_tr_b16 v[200:201], v9 offset:0
    ds_read_b64_tr_b16 v[202:203], v9 offset:2048
    ds_read_b64_tr_b16 v[204:205], v10 offset:0
    ds_read_b64_tr_b16 v[206:207], v10 offset:2048
    s_waitcnt lgkmcnt(0)
    v_mfma_f32_16x16x32_bf16 v[112:115], v[244:247], v[224:227], v[112:115]
    ds_read_b128 v[240:243], v6 offset:4096
    v_mfma_f32_16x16x32_bf16 v[132:135], v[248:251], v[224:227], v[132:135]
    v_mfma_f32_16x16x32_bf16 v[116:119], v[244:247], v[228:231], v[116:119]
    v_add_u32 v5, s30, v11
    ds_read_b128 v[224:227], v5 offset:0
    v_mfma_f32_16x16x32_bf16 v[136:139], v[248:251], v[228:231], v[136:139]
    v_mfma_f32_16x16x32_bf16 v[120:123], v[244:247], v[232:235], v[120:123]
    ds_read_b128 v[228:231], v5 offset:1024
    v_mfma_f32_16x16x32_bf16 v[140:143], v[248:251], v[232:235], v[140:143]
    v_mfma_f32_16x16x32_bf16 v[124:127], v[244:247], v[236:239], v[124:127]
    ds_read_b128 v[232:235], v5 offset:2048
    v_mfma_f32_16x16x32_bf16 v[144:147], v[248:251], v[236:239], v[144:147]
    s_waitcnt lgkmcnt(3)
    v_mfma_f32_16x16x32_bf16 v[128:131], v[244:247], v[240:243], v[128:131]
    ds_read_b128 v[236:239], v5 offset:3072
    v_mfma_f32_16x16x32_bf16 v[148:151], v[248:251], v[240:243], v[148:151]
    s_waitcnt vmcnt(0)
    ds_read_b64_tr_b16 v[208:209], v7 offset:4096
    ds_read_b64_tr_b16 v[210:211], v7 offset:6144
    ds_read_b64_tr_b16 v[212:213], v8 offset:4096
    ds_read_b64_tr_b16 v[214:215], v8 offset:6144
    ds_read_b64_tr_b16 v[216:217], v9 offset:4096
    ds_read_b64_tr_b16 v[218:219], v9 offset:6144
    ds_read_b64_tr_b16 v[220:221], v10 offset:4096
    ds_read_b64_tr_b16 v[222:223], v10 offset:6144
    s_waitcnt lgkmcnt(0)
    v_mfma_f32_16x16x32_bf16 v[112:115], v[192:195], v[224:227], v[112:115]
    ds_read_b128 v[240:243], v5 offset:4096
    v_mfma_f32_16x16x32_bf16 v[132:135], v[196:199], v[224:227], v[132:135]
    v_mfma_f32_16x16x32_bf16 v[116:119], v[192:195], v[228:231], v[116:119]
    v_add_u32 v6, s31, v11
    ds_read_b128 v[224:227], v6 offset:0
    v_mfma_f32_16x16x32_bf16 v[136:139], v[196:199], v[228:231], v[136:139]
    v_mfma_f32_16x16x32_bf16 v[120:123], v[192:195], v[232:235], v[120:123]
    ds_read_b128 v[228:231], v6 offset:1024
    v_mfma_f32_16x16x32_bf16 v[140:143], v[196:199], v[232:235], v[140:143]
    v_mfma_f32_16x16x32_bf16 v[124:127], v[192:195], v[236:239], v[124:127]
    ds_read_b128 v[232:235], v6 offset:2048
    v_mfma_f32_16x16x32_bf16 v[144:147], v[196:199], v[236:239], v[144:147]
    s_waitcnt lgkmcnt(3)
    v_mfma_f32_16x16x32_bf16 v[128:131], v[192:195], v[240:243], v[128:131]
    ds_read_b128 v[236:239], v6 offset:3072
    v_mfma_f32_16x16x32_bf16 v[148:151], v[196:199], v[240:243], v[148:151]
    s_waitcnt lgkmcnt(3)
    v_mfma_f32_16x16x32_bf16 v[112:115], v[208:211], v[224:227], v[112:115]
    ds_read_b128 v[240:243], v6 offset:4096
    v_mfma_f32_16x16x32_bf16 v[132:135], v[212:215], v[224:227], v[132:135]
    s_waitcnt lgkmcnt(3)
    v_mfma_f32_16x16x32_bf16 v[116:119], v[208:211], v[228:231], v[116:119]
    v_add_u32 v5, s24, v11
    ds_read_b128 v[224:227], v5 offset:0
    v_mfma_f32_16x16x32_bf16 v[136:139], v[212:215], v[228:231], v[136:139]
    s_waitcnt lgkmcnt(3)
    v_mfma_f32_16x16x32_bf16 v[120:123], v[208:211], v[232:235], v[120:123]
    ds_read_b128 v[228:231], v5 offset:1024
    v_mfma_f32_16x16x32_bf16 v[140:143], v[212:215], v[232:235], v[140:143]
    s_waitcnt lgkmcnt(3)
    v_mfma_f32_16x16x32_bf16 v[124:127], v[208:211], v[236:239], v[124:127]
    ds_read_b128 v[232:235], v5 offset:2048
    v_mfma_f32_16x16x32_bf16 v[144:147], v[212:215], v[236:239], v[144:147]
    s_waitcnt lgkmcnt(3)
    v_mfma_f32_16x16x32_bf16 v[128:131], v[208:211], v[240:243], v[128:131]
    ds_read_b128 v[236:239], v5 offset:3072
    v_mfma_f32_16x16x32_bf16 v[148:151], v[212:215], v[240:243], v[148:151]
    s_waitcnt lgkmcnt(3)
    v_mfma_f32_16x16x32_bf16 v[152:155], v[40:43], v[224:227], 0
    ds_read_b128 v[240:243], v5 offset:4096
    v_mfma_f32_16x16x32_bf16 v[172:175], v[44:47], v[224:227], 0
    s_waitcnt lgkmcnt(3)
    v_mfma_f32_16x16x32_bf16 v[156:159], v[40:43], v[228:231], 0
    v_add_u32 v6, s25, v11
    ds_read_b128 v[224:227], v6 offset:0
    v_mfma_f32_16x16x32_bf16 v[176:179], v[44:47], v[228:231], 0
    s_waitcnt lgkmcnt(3)
    v_mfma_f32_16x16x32_bf16 v[160:163], v[40:43], v[232:235], 0
    ds_read_b128 v[228:231], v6 offset:1024
    v_mfma_f32_16x16x32_bf16 v[180:183], v[44:47], v[232:235], 0
    s_waitcnt lgkmcnt(3)
    v_mfma_f32_16x16x32_bf16 v[164:167], v[40:43], v[236:239], 0
    ds_read_b128 v[232:235], v6 offset:2048
    v_mfma_f32_16x16x32_bf16 v[184:187], v[44:47], v[236:239], 0
    s_waitcnt lgkmcnt(3)
    v_mfma_f32_16x16x32_bf16 v[168:171], v[40:43], v[240:243], 0
    ds_read_b128 v[236:239], v6 offset:3072
    v_cvt_pk_bf16_f32 v112, v112, v113
    v_mfma_f32_16x16x32_bf16 v[188:191], v[44:47], v[240:243], 0
    v_cvt_pk_bf16_f32 v113, v114, v115
    s_waitcnt lgkmcnt(3)
    v_mfma_f32_16x16x32_bf16 v[152:155], v[56:59], v[224:227], v[152:155]
    ds_read_b128 v[240:243], v6 offset:4096
    v_cvt_pk_bf16_f32 v114, v132, v133
    v_mfma_f32_16x16x32_bf16 v[172:175], v[60:63], v[224:227], v[172:175]
    v_cvt_pk_bf16_f32 v115, v134, v135
    s_waitcnt lgkmcnt(3)
    v_mfma_f32_16x16x32_bf16 v[156:159], v[56:59], v[228:231], v[156:159]
    v_add_u32 v5, s26, v11
    ds_read_b128 v[224:227], v5 offset:0
    s_add_u32 s49, s67, 0
    v_mfma_f32_16x16x32_bf16 v[176:179], v[60:63], v[228:231], v[176:179]
    buffer_store_dwordx4 v[112:115], v2, s[44:47], s49 offen sc1
    s_waitcnt lgkmcnt(3)
    v_mfma_f32_16x16x32_bf16 v[160:163], v[56:59], v[232:235], v[160:163]
    ds_read_b128 v[228:231], v5 offset:1024
    v_cvt_pk_bf16_f32 v116, v116, v117
    v_mfma_f32_16x16x32_bf16 v[180:183], v[60:63], v[232:235], v[180:183]
    v_cvt_pk_bf16_f32 v117, v118, v119
    s_waitcnt lgkmcnt(3)
    v_mfma_f32_16x16x32_bf16 v[164:167], v[56:59], v[236:239], v[164:167]
    ds_read_b128 v[232:235], v5 offset:2048
    v_cvt_pk_bf16_f32 v118, v136, v137
    v_mfma_f32_16x16x32_bf16 v[184:187], v[60:63], v[236:239], v[184:187]
    v_cvt_pk_bf16_f32 v119, v138, v139
    s_waitcnt lgkmcnt(3)
    v_mfma_f32_16x16x32_bf16 v[168:171], v[56:59], v[240:243], v[168:171]
    ds_read_b128 v[236:239], v5 offset:3072
    s_add_u32 s49, s67, 2048
    v_mfma_f32_16x16x32_bf16 v[188:191], v[60:63], v[240:243], v[188:191]
    buffer_store_dwordx4 v[116:119], v2, s[44:47], s49 offen sc1
    s_waitcnt lgkmcnt(3)
    v_mfma_f32_16x16x32_bf16 v[152:155], v[72:75], v[224:227], v[152:155]
    ds_read_b128 v[240:243], v5 offset:4096
    v_cvt_pk_bf16_f32 v120, v120, v121
    v_mfma_f32_16x16x32_bf16 v[172:175], v[76:79], v[224:227], v[172:175]
    v_cvt_pk_bf16_f32 v121, v122, v123
    s_waitcnt lgkmcnt(3)
    v_mfma_f32_16x16x32_bf16 v[156:159], v[72:75], v[228:231], v[156:159]
    v_add_u32 v6, s27, v11
    ds_read_b128 v[224:227], v6 offset:0
    v_cvt_pk_bf16_f32 v122, v140, v141
    v_mfma_f32_16x16x32_bf16 v[176:179], v[76:79], v[228:231], v[176:179]
    v_cvt_pk_bf16_f32 v123, v142, v143
    s_waitcnt lgkmcnt(3)
    v_mfma_f32_16x16x32_bf16 v[160:163], v[72:75], v[232:235], v[160:163]
    ds_read_b128 v[228:231], v6 offset:1024
    s_add_u32 s49, s67, 4096
    v_mfma_f32_16x16x32_bf16 v[180:183], v[76:79], v[232:235], v[180:183]
    buffer_store_dwordx4 v[120:123], v2, s[44:47], s49 offen sc1
    s_waitcnt lgkmcnt(3)
    v_mfma_f32_16x16x32_bf16 v[164:167], v[72:75], v[236:239], v[164:167]
    ds_read_b128 v[232:235], v6 offset:2048
    v_cvt_pk_bf16_f32 v124, v124, v125
    v_mfma_f32_16x16x32_bf16 v[184:187], v[76:79], v[236:239], v[184:187]
    v_cvt_pk_bf16_f32 v125, v126, v127
    s_waitcnt lgkmcnt(3)
    v_mfma_f32_16x16x32_bf16 v[168:171], v[72:75], v[240:243], v[168:171]
    ds_read_b128 v[236:239], v6 offset:3072
    v_cvt_pk_bf16_f32 v126, v144, v145
    v_mfma_f32_16x16x32_bf16 v[188:191], v[76:79], v[240:243], v[188:191]
    v_cvt_pk_bf16_f32 v127, v146, v147
    s_waitcnt lgkmcnt(3)
    v_mfma_f32_16x16x32_bf16 v[152:155], v[88:91], v[224:227], v[152:155]
    ds_read_b128 v[240:243], v6 offset:4096
    s_add_u32 s49, s67, 6144
    v_mfma_f32_16x16x32_bf16 v[172:175], v[92:95], v[224:227], v[172:175]
    buffer_store_dwordx4 v[124:127], v2, s[44:47], s49 offen sc1
    s_waitcnt lgkmcnt(3)
    v_mfma_f32_16x16x32_bf16 v[156:159], v[88:91], v[228:231], v[156:159]
    v_add_u32 v5, s28, v11
    ds_read_b128 v[224:227], v5 offset:0
    v_cvt_pk_bf16_f32 v128, v128, v129
    v_mfma_f32_16x16x32_bf16 v[176:179], v[92:95], v[228:231], v[176:179]
    v_cvt_pk_bf16_f32 v129, v130, v131
    s_waitcnt lgkmcnt(3)
    v_mfma_f32_16x16x32_bf16 v[160:163], v[88:91], v[232:235], v[160:163]
    ds_read_b128 v[228:231], v5 offset:1024
    v_cvt_pk_bf16_f32 v130, v148, v149
    v_mfma_f32_16x16x32_bf16 v[180:183], v[92:95], v[232:235], v[180:183]
    v_cvt_pk_bf16_f32 v131, v150, v151
    s_waitcnt lgkmcnt(3)
    v_mfma_f32_16x16x32_bf16 v[164:167], v[88:91], v[236:239], v[164:167]
    ds_read_b128 v[232:235], v5 offset:2048
    s_add_u32 s49, s67, 8192
    v_mfma_f32_16x16x32_bf16 v[184:187], v[92:95], v[236:239], v[184:187]
    buffer_store_dwordx4 v[128:131], v2, s[44:47], s49 offen sc1
    s_waitcnt lgkmcnt(3)
    v_mfma_f32_16x16x32_bf16 v[168:171], v[88:91], v[240:243], v[168:171]
    ds_read_b128 v[236:239], v5 offset:3072
    v_mfma_f32_16x16x32_bf16 v[188:191], v[92:95], v[240:243], v[188:191]
    s_waitcnt lgkmcnt(3)
    v_mfma_f32_16x16x32_bf16 v[152:155], v[104:107], v[224:227], v[152:155]
    ds_read_b128 v[240:243], v5 offset:4096
    v_mfma_f32_16x16x32_bf16 v[172:175], v[108:111], v[224:227], v[172:175]
    s_waitcnt lgkmcnt(3)
    v_mfma_f32_16x16x32_bf16 v[156:159], v[104:107], v[228:231], v[156:159]
    v_add_u32 v6, s29, v11
    ds_read_b128 v[224:227], v6 offset:0
    v_mfma_f32_16x16x32_bf16 v[176:179], v[108:111], v[228:231], v[176:179]
    s_waitcnt lgkmcnt(3)
    v_mfma_f32_16x16x32_bf16 v[160:163], v[104:107], v[232:235], v[160:163]
    ds_read_b128 v[228:231], v6 offset:1024
    v_mfma_f32_16x16x32_bf16 v[180:183], v[108:111], v[232:235], v[180:183]
    s_waitcnt lgkmcnt(3)
    v_mfma_f32_16x16x32_bf16 v[164:167], v[104:107], v[236:239], v[164:167]
    ds_read_b128 v[232:235], v6 offset:2048
    v_mfma_f32_16x16x32_bf16 v[184:187], v[108:111], v[236:239], v[184:187]
    s_waitcnt lgkmcnt(3)
    v_mfma_f32_16x16x32_bf16 v[168:171], v[104:107], v[240:243], v[168:171]
    ds_read_b128 v[236:239], v6 offset:3072
    v_mfma_f32_16x16x32_bf16 v[188:191], v[108:111], v[240:243], v[188:191]
    s_waitcnt lgkmcnt(3)
    v_mfma_f32_16x16x32_bf16 v[152:155], v[252:255], v[224:227], v[152:155]
    ds_read_b128 v[240:243], v6 offset:4096
    v_mfma_f32_16x16x32_bf16 v[172:175], v[16:19], v[224:227], v[172:175]
    s_waitcnt lgkmcnt(3)
    v_mfma_f32_16x16x32_bf16 v[156:159], v[252:255], v[228:231], v[156:159]
    v_add_u32 v5, s30, v11
    ds_read_b128 v[224:227], v5 offset:0
    v_mfma_f32_16x16x32_bf16 v[176:179], v[16:19], v[228:231], v[176:179]
    s_waitcnt lgkmcnt(3)
    v_mfma_f32_16x16x32_bf16 v[160:163], v[252:255], v[232:235], v[160:163]
    ds_read_b128 v[228:231], v5 offset:1024
    v_mfma_f32_16x16x32_bf16 v[180:183], v[16:19], v[232:235], v[180:183]
    s_waitcnt lgkmcnt(3)
    v_mfma_f32_16x16x32_bf16 v[164:167], v[252:255], v[236:239], v[164:167]
    ds_read_b128 v[232:235], v5 offset:2048
    v_mfma_f32_16x16x32_bf16 v[184:187], v[16:19], v[236:239], v[184:187]
    s_waitcnt lgkmcnt(3)
    v_mfma_f32_16x16x32_bf16 v[168:171], v[252:255], v[240:243], v[168:171]
    ds_read_b128 v[236:239], v5 offset:3072
    v_mfma_f32_16x16x32_bf16 v[188:191], v[16:19], v[240:243], v[188:191]
    s_waitcnt lgkmcnt(3)
    v_mfma_f32_16x16x32_bf16 v[152:155], v[200:203], v[224:227], v[152:155]
    ds_read_b128 v[240:243], v5 offset:4096
    v_mfma_f32_16x16x32_bf16 v[172:175], v[204:207], v[224:227], v[172:175]
    s_waitcnt lgkmcnt(3)
    v_mfma_f32_16x16x32_bf16 v[156:159], v[200:203], v[228:231], v[156:159]
    v_add_u32 v6, s31, v11
    ds_read_b128 v[224:227], v6 offset:0
    v_mfma_f32_16x16x32_bf16 v[176:179], v[204:207], v[228:231], v[176:179]
    s_waitcnt lgkmcnt(3)
    v_mfma_f32_16x16x32_bf16 v[160:163], v[200:203], v[232:235], v[160:163]
    ds_read_b128 v[228:231], v6 offset:1024
    v_mfma_f32_16x16x32_bf16 v[180:183], v[204:207], v[232:235], v[180:183]
    s_waitcnt lgkmcnt(3)
    v_mfma_f32_16x16x32_bf16 v[164:167], v[200:203], v[236:239], v[164:167]
    ds_read_b128 v[232:235], v6 offset:2048
    v_mfma_f32_16x16x32_bf16 v[184:187], v[204:207], v[236:239], v[184:187]
    s_waitcnt lgkmcnt(3)
    v_mfma_f32_16x16x32_bf16 v[168:171], v[200:203], v[240:243], v[168:171]
    ds_read_b128 v[236:239], v6 offset:3072
    v_mfma_f32_16x16x32_bf16 v[188:191], v[204:207], v[240:243], v[188:191]
    s_waitcnt lgkmcnt(3)
    v_mfma_f32_16x16x32_bf16 v[152:155], v[216:219], v[224:227], v[152:155]
    ds_read_b128 v[240:243], v6 offset:4096
    v_mfma_f32_16x16x32_bf16 v[172:175], v[220:223], v[224:227], v[172:175]
    s_waitcnt lgkmcnt(3)
    v_mfma_f32_16x16x32_bf16 v[156:159], v[216:219], v[228:231], v[156:159]
    v_mfma_f32_16x16x32_bf16 v[176:179], v[220:223], v[228:231], v[176:179]
    s_waitcnt lgkmcnt(2)
    v_mfma_f32_16x16x32_bf16 v[160:163], v[216:219], v[232:235], v[160:163]
    v_mfma_f32_16x16x32_bf16 v[180:183], v[220:223], v[232:235], v[180:183]
    s_waitcnt lgkmcnt(1)
    v_mfma_f32_16x16x32_bf16 v[164:167], v[216:219], v[236:239], v[164:167]
    v_mfma_f32_16x16x32_bf16 v[184:187], v[220:223], v[236:239], v[184:187]
    s_waitcnt lgkmcnt(0)
    v_mfma_f32_16x16x32_bf16 v[168:171], v[216:219], v[240:243], v[168:171]
    v_mfma_f32_16x16x32_bf16 v[188:191], v[220:223], v[240:243], v[188:191]
    v_cvt_pk_bf16_f32 v152, v152, v153
    v_cvt_pk_bf16_f32 v153, v154, v155
    v_cvt_pk_bf16_f32 v154, v172, v173
    v_cvt_pk_bf16_f32 v155, v174, v175
    s_add_u32 s49, s67, 0
    buffer_store_dwordx4 v[152:155], v3, s[44:47], s49 offen sc1
    v_cvt_pk_bf16_f32 v156, v156, v157
    v_cvt_pk_bf16_f32 v157, v158, v159
    v_cvt_pk_bf16_f32 v158, v176, v177
    v_cvt_pk_bf16_f32 v159, v178, v179
    s_add_u32 s49, s67, 2048
    buffer_store_dwordx4 v[156:159], v3, s[44:47], s49 offen sc1
    v_cvt_pk_bf16_f32 v160, v160, v161
    v_cvt_pk_bf16_f32 v161, v162, v163
    v_cvt_pk_bf16_f32 v162, v180, v181
    v_cvt_pk_bf16_f32 v163, v182, v183
    s_add_u32 s49, s67, 4096
    buffer_store_dwordx4 v[160:163], v3, s[44:47], s49 offen sc1
    v_cvt_pk_bf16_f32 v164, v164, v165
    v_cvt_pk_bf16_f32 v165, v166, v167
    v_cvt_pk_bf16_f32 v166, v184, v185
    v_cvt_pk_bf16_f32 v167, v186, v187
    s_add_u32 s49, s67, 6144
    buffer_store_dwordx4 v[164:167], v3, s[44:47], s49 offen sc1
    v_cvt_pk_bf16_f32 v168, v168, v169
    v_cvt_pk_bf16_f32 v169, v170, v171
    v_cvt_pk_bf16_f32 v170, v188, v189
    v_cvt_pk_bf16_f32 v171, v190, v191
    s_add_u32 s49, s67, 8192
    buffer_store_dwordx4 v[168:171], v3, s[44:47], s49 offen sc1
    s_branch L_stored
L_w7:
    s_lshr_b32 s50, s2, 4
    s_lshl_b32 s50, s50, 4
    v_mov_b32 v32, s50
    s_mov_b32 s51, 0
    s_mov_b64 exec, 1
L_ipoll:
    global_load_dword v34, v32, s[58:59] sc1
    s_waitcnt vmcnt(0)
    v_readfirstlane_b32 s52, v34
    s_add_u32 s51, s51, 1
    s_nop 1
    s_and_b32 s53, s52, 15
    s_cmp_eq_u32 s53, 0
    s_cselect_b32 s53, s52, 0
    s_cmp_lg_u32 s53, 0
    s_cbranch_scc1 L_idone
    s_sleep 8
    s_cmp_lt_u32 s51, 0x100000
    s_cbranch_scc1 L_ipoll
L_idone:
    s_mov_b64 exec, -1
L_stored:
    s_waitcnt vmcnt(0)
    s_barrier
    s_cmp_lg_u32 s9, 0
    s_cbranch_scc1 L_go
    s_lshr_b32 s50, s2, 4
    s_lshl_b32 s51, s50, 4
    v_mov_b32 v32, s51
    v_mov_b32 v33, 1
    s_lshl_b32 s50, s50, 11
    v_lshl_add_u32 v35, v1, 7, s50
    s_lshl_b32 s51, s2, 7
    v_mov_b32 v36, s51
    s_mov_b64 exec, 0xffff
    global_atomic_add v35, v33, s[64:65]
    s_mov_b64 exec, 1
    s_mov_b32 s51, 0
L_poll:
    global_load_dword v34, v36, s[64:65] sc1
    s_waitcnt vmcnt(0)
    v_readfirstlane_b32 s52, v34
    s_add_u32 s51, s51, 1
    s_nop 1
    s_cmp_eq_u32 s52, 16
    s_cbranch_scc1 L_polled
    s_cmp_lt_u32 s51, 0x200000
    s_cbranch_scc1 L_poll
L_polled:
    s_mov_b64 exec, -1
L_go:
    s_barrier
    s_lshl_b32 s50, s9, 4
    s_add_u32 s50, s50, s8
    s_cmp_ge_u32 s50, 70
    s_cbranch_scc1 L_fin
    s_lshl_b32 s51, s50, 10
    s_add_u32 s52, s51, 0
    buffer_load_dwordx4 v[40:43], v0, s[44:47], s52 offen sc1
    s_add_u32 s53, s51, 71680
    buffer_load_dwordx4 v[44:47], v0, s[44:47], s53 offen sc1
    s_add_u32 s52, s51, 143360
    buffer_load_dwordx4 v[48:51], v0, s[44:47], s52 offen sc1
    s_add_u32 s53, s51, 215040
    buffer_load_dwordx4 v[52:55], v0, s[44:47], s53 offen sc1
    s_add_u32 s52, s51, 286720
    buffer_load_dwordx4 v[56:59], v0, s[44:47], s52 offen sc1
    s_add_u32 s53, s51, 358400
    buffer_load_dwordx4 v[60:63], v0, s[44:47], s53 offen sc1
    s_add_u32 s52, s51, 430080
    buffer_load_dwordx4 v[64:67], v0, s[44:47], s52 offen sc1
    s_add_u32 s53, s51, 501760
    buffer_load_dwordx4 v[68:71], v0, s[44:47], s53 offen sc1
    s_add_u32 s52, s51, 573440
    buffer_load_dwordx4 v[72:75], v0, s[44:47], s52 offen sc1
    s_add_u32 s53, s51, 645120
    buffer_load_dwordx4 v[76:79], v0, s[44:47], s53 offen sc1
    s_add_u32 s52, s51, 716800
    buffer_load_dwordx4 v[80:83], v0, s[44:47], s52 offen sc1
    s_add_u32 s53, s51, 788480
    buffer_load_dwordx4 v[84:87], v0, s[44:47], s53 offen sc1
    s_add_u32 s52, s51, 860160
    buffer_load_dwordx4 v[88:91], v0, s[44:47], s52 offen sc1
    s_add_u32 s53, s51, 931840
    buffer_load_dwordx4 v[92:95], v0, s[44:47], s53 offen sc1
    s_add_u32 s52, s51, 1003520
    buffer_load_dwordx4 v[96:99], v0, s[44:47], s52 offen sc1
    s_add_u32 s53, s51, 1075200
    buffer_load_dwordx4 v[100:103], v0, s[44:47], s53 offen sc1
    s_lshr_b32 s51, s50, 1
    s_and_b32 s52, s50, 1
    s_mul_i32 s53, s51, 52
    s_lshr_b32 s53, s53, 8
    s_mul_i32 s30, s53, 5
    s_sub_u32 s51, s51, s30
    s_mul_i32 s30, s6, 80
    s_lshl_b32 s51, s51, 4
    s_add_u32 s30, s30, s51
    s_mul_i32 s30, s30, 1792
    s_mul_i32 s51, s5, 896
    s_add_u32 s30, s30, s51
    s_lshl_b32 s53, s53, 7
    s_add_u32 s30, s30, s53
    s_lshl_b32 s52, s52, 6
    s_add_u32 s30, s30, s52
    s_mov_b32 s24, s56
    s_mov_b32 s25, s57
    s_mov_b32 s26, 1146880
    s_mov_b32 s27, 0x00020000
    s_mov_b32 s31, 0xffff0000
    v_and_b32 v2, 15, v1
    v_mul_u32_u24 v2, 1792, v2
    v_lshrrev_b32 v3, 4, v1
    v_lshl_add_u32 v2, v3, 3, v2
    s_waitcnt vmcnt(15)
    v_lshlrev_b32 v8, 16, v40
    v_and_b32 v9, s31, v40
    v_lshlrev_b32 v10, 16, v41
    v_and_b32 v11, s31, v41
    v_lshlrev_b32 v12, 16, v42
    v_and_b32 v13, s31, v42
    v_lshlrev_b32 v14, 16, v43
    v_and_b32 v15, s31, v43
    s_waitcnt vmcnt(14)
    v_lshlrev_b32 v4, 16, v44
    v_and_b32 v5, s31, v44
    v_add_f32 v8, v8, v4
    v_add_f32 v9, v9, v5
    v_lshlrev_b32 v6, 16, v45
    v_and_b32 v7, s31, v45
    v_add_f32 v10, v10, v6
    v_add_f32 v11, v11, v7
    v_lshlrev_b32 v4, 16, v46
    v_and_b32 v5, s31, v46
    v_add_f32 v12, v12, v4
    v_add_f32 v13, v13, v5
    v_lshlrev_b32 v6, 16, v47
    v_and_b32 v7, s31, v47
    v_add_f32 v14, v14, v6
    v_add_f32 v15, v15, v7
    s_waitcnt vmcnt(13)
    v_lshlrev_b32 v4, 16, v48
    v_and_b32 v5, s31, v48
    v_add_f32 v8, v8, v4
    v_add_f32 v9, v9, v5
    v_lshlrev_b32 v6, 16, v49
    v_and_b32 v7, s31, v49
    v_add_f32 v10, v10, v6
    v_add_f32 v11, v11, v7
    v_lshlrev_b32 v4, 16, v50
    v_and_b32 v5, s31, v50
    v_add_f32 v12, v12, v4
    v_add_f32 v13, v13, v5
    v_lshlrev_b32 v6, 16, v51
    v_and_b32 v7, s31, v51
    v_add_f32 v14, v14, v6
    v_add_f32 v15, v15, v7
    s_waitcnt vmcnt(12)
    v_lshlrev_b32 v4, 16, v52
    v_and_b32 v5, s31, v52
    v_add_f32 v8, v8, v4
    v_add_f32 v9, v9, v5
    v_lshlrev_b32 v6, 16, v53
    v_and_b32 v7, s31, v53
    v_add_f32 v10, v10, v6
    v_add_f32 v11, v11, v7
    v_lshlrev_b32 v4, 16, v54
    v_and_b32 v5, s31, v54
    v_add_f32 v12, v12, v4
    v_add_f32 v13, v13, v5
    v_lshlrev_b32 v6, 16, v55
    v_and_b32 v7, s31, v55
    v_add_f32 v14, v14, v6
    v_add_f32 v15, v15, v7
    s_waitcnt vmcnt(11)
    v_lshlrev_b32 v4, 16, v56
    v_and_b32 v5, s31, v56
    v_add_f32 v8, v8, v4
    v_add_f32 v9, v9, v5
    v_lshlrev_b32 v6, 16, v57
    v_and_b32 v7, s31, v57
    v_add_f32 v10, v10, v6
    v_add_f32 v11, v11, v7
    v_lshlrev_b32 v4, 16, v58
    v_and_b32 v5, s31, v58
    v_add_f32 v12, v12, v4
    v_add_f32 v13, v13, v5
    v_lshlrev_b32 v6, 16, v59
    v_and_b32 v7, s31, v59
    v_add_f32 v14, v14, v6
    v_add_f32 v15, v15, v7
    s_waitcnt vmcnt(10)
    v_lshlrev_b32 v4, 16, v60
    v_and_b32 v5, s31, v60
    v_add_f32 v8, v8, v4
    v_add_f32 v9, v9, v5
    v_lshlrev_b32 v6, 16, v61
    v_and_b32 v7, s31, v61
    v_add_f32 v10, v10, v6
    v_add_f32 v11, v11, v7
    v_lshlrev_b32 v4, 16, v62
    v_and_b32 v5, s31, v62
    v_add_f32 v12, v12, v4
    v_add_f32 v13, v13, v5
    v_lshlrev_b32 v6, 16, v63
    v_and_b32 v7, s31, v63
    v_add_f32 v14, v14, v6
    v_add_f32 v15, v15, v7
    s_waitcnt vmcnt(9)
    v_lshlrev_b32 v4, 16, v64
    v_and_b32 v5, s31, v64
    v_add_f32 v8, v8, v4
    v_add_f32 v9, v9, v5
    v_lshlrev_b32 v6, 16, v65
    v_and_b32 v7, s31, v65
    v_add_f32 v10, v10, v6
    v_add_f32 v11, v11, v7
    v_lshlrev_b32 v4, 16, v66
    v_and_b32 v5, s31, v66
    v_add_f32 v12, v12, v4
    v_add_f32 v13, v13, v5
    v_lshlrev_b32 v6, 16, v67
    v_and_b32 v7, s31, v67
    v_add_f32 v14, v14, v6
    v_add_f32 v15, v15, v7
    s_waitcnt vmcnt(8)
    v_lshlrev_b32 v4, 16, v68
    v_and_b32 v5, s31, v68
    v_add_f32 v8, v8, v4
    v_add_f32 v9, v9, v5
    v_lshlrev_b32 v6, 16, v69
    v_and_b32 v7, s31, v69
    v_add_f32 v10, v10, v6
    v_add_f32 v11, v11, v7
    v_lshlrev_b32 v4, 16, v70
    v_and_b32 v5, s31, v70
    v_add_f32 v12, v12, v4
    v_add_f32 v13, v13, v5
    v_lshlrev_b32 v6, 16, v71
    v_and_b32 v7, s31, v71
    v_add_f32 v14, v14, v6
    v_add_f32 v15, v15, v7
    s_waitcnt vmcnt(7)
    v_lshlrev_b32 v4, 16, v72
    v_and_b32 v5, s31, v72
    v_add_f32 v8, v8, v4
    v_add_f32 v9, v9, v5
    v_lshlrev_b32 v6, 16, v73
    v_and_b32 v7, s31, v73
    v_add_f32 v10, v10, v6
    v_add_f32 v11, v11, v7
    v_lshlrev_b32 v4, 16, v74
    v_and_b32 v5, s31, v74
    v_add_f32 v12, v12, v4
    v_add_f32 v13, v13, v5
    v_lshlrev_b32 v6, 16, v75
    v_and_b32 v7, s31, v75
    v_add_f32 v14, v14, v6
    v_add_f32 v15, v15, v7
    s_waitcnt vmcnt(6)
    v_lshlrev_b32 v4, 16, v76
    v_and_b32 v5, s31, v76
    v_add_f32 v8, v8, v4
    v_add_f32 v9, v9, v5
    v_lshlrev_b32 v6, 16, v77
    v_and_b32 v7, s31, v77
    v_add_f32 v10, v10, v6
    v_add_f32 v11, v11, v7
    v_lshlrev_b32 v4, 16, v78
    v_and_b32 v5, s31, v78
    v_add_f32 v12, v12, v4
    v_add_f32 v13, v13, v5
    v_lshlrev_b32 v6, 16, v79
    v_and_b32 v7, s31, v79
    v_add_f32 v14, v14, v6
    v_add_f32 v15, v15, v7
    s_waitcnt vmcnt(5)
    v_lshlrev_b32 v4, 16, v80
    v_and_b32 v5, s31, v80
    v_add_f32 v8, v8, v4
    v_add_f32 v9, v9, v5
    v_lshlrev_b32 v6, 16, v81
    v_and_b32 v7, s31, v81
    v_add_f32 v10, v10, v6
    v_add_f32 v11, v11, v7
    v_lshlrev_b32 v4, 16, v82
    v_and_b32 v5, s31, v82
    v_add_f32 v12, v12, v4
    v_add_f32 v13, v13, v5
    v_lshlrev_b32 v6, 16, v83
    v_and_b32 v7, s31, v83
    v_add_f32 v14, v14, v6
    v_add_f32 v15, v15, v7
    s_waitcnt vmcnt(4)
    v_lshlrev_b32 v4, 16, v84
    v_and_b32 v5, s31, v84
    v_add_f32 v8, v8, v4
    v_add_f32 v9, v9, v5
    v_lshlrev_b32 v6, 16, v85
    v_and_b32 v7, s31, v85
    v_add_f32 v10, v10, v6
    v_add_f32 v11, v11, v7
    v_lshlrev_b32 v4, 16, v86
    v_and_b32 v5, s31, v86
    v_add_f32 v12, v12, v4
    v_add_f32 v13, v13, v5
    v_lshlrev_b32 v6, 16, v87
    v_and_b32 v7, s31, v87
    v_add_f32 v14, v14, v6
    v_add_f32 v15, v15, v7
    s_waitcnt vmcnt(3)
    v_lshlrev_b32 v4, 16, v88
    v_and_b32 v5, s31, v88
    v_add_f32 v8, v8, v4
    v_add_f32 v9, v9, v5
    v_lshlrev_b32 v6, 16, v89
    v_and_b32 v7, s31, v89
    v_add_f32 v10, v10, v6
    v_add_f32 v11, v11, v7
    v_lshlrev_b32 v4, 16, v90
    v_and_b32 v5, s31, v90
    v_add_f32 v12, v12, v4
    v_add_f32 v13, v13, v5
    v_lshlrev_b32 v6, 16, v91
    v_and_b32 v7, s31, v91
    v_add_f32 v14, v14, v6
    v_add_f32 v15, v15, v7
    s_waitcnt vmcnt(2)
    v_lshlrev_b32 v4, 16, v92
    v_and_b32 v5, s31, v92
    v_add_f32 v8, v8, v4
    v_add_f32 v9, v9, v5
    v_lshlrev_b32 v6, 16, v93
    v_and_b32 v7, s31, v93
    v_add_f32 v10, v10, v6
    v_add_f32 v11, v11, v7
    v_lshlrev_b32 v4, 16, v94
    v_and_b32 v5, s31, v94
    v_add_f32 v12, v12, v4
    v_add_f32 v13, v13, v5
    v_lshlrev_b32 v6, 16, v95
    v_and_b32 v7, s31, v95
    v_add_f32 v14, v14, v6
    v_add_f32 v15, v15, v7
    s_waitcnt vmcnt(1)
    v_lshlrev_b32 v4, 16, v96
    v_and_b32 v5, s31, v96
    v_add_f32 v8, v8, v4
    v_add_f32 v9, v9, v5
    v_lshlrev_b32 v6, 16, v97
    v_and_b32 v7, s31, v97
    v_add_f32 v10, v10, v6
    v_add_f32 v11, v11, v7
    v_lshlrev_b32 v4, 16, v98
    v_and_b32 v5, s31, v98
    v_add_f32 v12, v12, v4
    v_add_f32 v13, v13, v5
    v_lshlrev_b32 v6, 16, v99
    v_and_b32 v7, s31, v99
    v_add_f32 v14, v14, v6
    v_add_f32 v15, v15, v7
    s_waitcnt vmcnt(0)
    v_lshlrev_b32 v4, 16, v100
    v_and_b32 v5, s31, v100
    v_add_f32 v8, v8, v4
    v_add_f32 v9, v9, v5
    v_lshlrev_b32 v6, 16, v101
    v_and_b32 v7, s31, v101
    v_add_f32 v10, v10, v6
    v_add_f32 v11, v11, v7
    v_lshlrev_b32 v4, 16, v102
    v_and_b32 v5, s31, v102
    v_add_f32 v12, v12, v4
    v_add_f32 v13, v13, v5
    v_lshlrev_b32 v6, 16, v103
    v_and_b32 v7, s31, v103
    v_add_f32 v14, v14, v6
    v_add_f32 v15, v15, v7
    v_cvt_pk_bf16_f32 v16, v8, v9
    v_cvt_pk_bf16_f32 v17, v10, v11
    v_cvt_pk_bf16_f32 v18, v12, v13
    v_cvt_pk_bf16_f32 v19, v14, v15
    buffer_store_dwordx2 v[16:17], v2, s[24:27], s30 offen nt
    buffer_store_dwordx2 v[18:19], v2, s[24:27], s30 offen offset:32 nt
L_fin:
L_end:
    s_endpgm
.section .rodata,"a"
.p2align 6
.amdhsa_kernel concat_heads__gqa_block_cached__gqa_block_cached__near_ridge_kernel
  .amdhsa_next_free_vgpr 256
  .amdhsa_next_free_sgpr 102
  .amdhsa_accum_offset 256
  .amdhsa_group_segment_fixed_size 0
  .amdhsa_kernarg_size 104
  .amdhsa_user_sgpr_count 2
  .amdhsa_user_sgpr_kernarg_segment_ptr 1
  .amdhsa_system_sgpr_workgroup_id_x 1
.end_amdhsa_kernel
```
